```python
import torch

def _softmax(x, axis=-1):
    return torch.softmax(x, dim=axis)
def _gelu(x):
    return torch.nn.functional.gelu(x, approximate="tanh")
def _silu(x):
    return torch.nn.functional.silu(x)
def _sigmoid(x):
    return torch.sigmoid(x)
def _layernorm(x, axis=-1, eps=1e-5):
    m = x.mean(dim=axis, keepdim=True)
    v = x.var(dim=axis, keepdim=True, unbiased=False)
    return (x - m) / torch.sqrt(v + eps)
def _scatter_add(tgt, idx, src, axis=0):
    return tgt.clone().index_add_(axis, idx, src)
def _segment_sum(src, seg, n):
    out = torch.zeros((n,) + src.shape[1:], dtype=src.dtype)
    return out.index_add_(0, seg, src)
def _pad(x, pw):
    flat = tuple(v for pair in reversed(pw) for v in pair)
    return torch.nn.functional.pad(x, flat)

kernel_name = 'interleave_layers__linear_kernel_hedgehog__mha_block__prompt'

def setup_inputs():

    _w = (lambda a: (lambda t: t.to(torch.bfloat16) if t.is_floating_point() else t)(torch.as_tensor(a)))
    def _A_setup():
        B, S, D, H = 1, 2048, 1024, 32
        Dh = D // H
        return {
            "x": _w((lambda *s: torch.randn(*s, dtype=torch.bfloat16) * 0.05)(B, S, D)),
            "wqkv": _w((lambda *s: torch.randn(*s, dtype=torch.bfloat16) * 0.2)(D, 3 * D)),
            "w_phi": _w((lambda *s: torch.randn(*s, dtype=torch.bfloat16) * 0.2)(H, Dh, Dh) * (Dh ** -0.5)),
            "wo": _w((lambda *s: torch.randn(*s, dtype=torch.bfloat16) * 0.05)(D, D)),
        }
    _A_in = _A_setup()

    def _B_setup():
        B, S, D, H = 1, 2048, 1024, 32
        return {
            "x": _w((lambda *s: torch.randn(*s, dtype=torch.bfloat16) * 0.05)(B, S, D)),
            "wqkv": _w((lambda *s: torch.randn(*s, dtype=torch.bfloat16) * 0.1)(D, 3 * D)),
            "wo": _w((lambda *s: torch.randn(*s, dtype=torch.bfloat16) * 0.05)(D, D)),
        }
    _B_in = _B_setup()

    return {
        "A_x": _A_in["x"],
        "A_wqkv": _A_in["wqkv"],
        "A_w_phi": _A_in["w_phi"],
        "A_wo": _A_in["wo"],
        "B_x": _B_in["x"],
        "B_wqkv": _B_in["wqkv"],
        "B_wo": _B_in["wo"],
    }

def reference(A_x, A_wqkv, A_w_phi, A_wo, B_x, B_wqkv, B_wo):
    def _A_ref(x, wqkv, w_phi, wo):
        B, S, D = x.shape
        H = 32; Dh = D // H
        qkv = (lambda x, *d: x.permute(*d))((x @ wqkv).reshape(B, S, 3, H, Dh), 2, 0, 3, 1, 4)
        q, k, v = qkv[0], qkv[1], qkv[2]
        pq = torch.einsum("bhsd,hdf->bhsf", q, w_phi)
        pk = torch.einsum("bhsd,hdf->bhsf", k, w_phi)
        phi_q = torch.concatenate([_softmax(pq, axis=-1), _softmax(-pq, axis=-1)], axis=-1)
        phi_k = torch.concatenate([_softmax(pk, axis=-1), _softmax(-pk, axis=-1)], axis=-1)
        kv = torch.einsum("bhsf,bhsd->bhfd", phi_k, v)
        z  = torch.einsum("bhsf->bhf", phi_k)
        num = torch.einsum("bhqf,bhfd->bhqd", phi_q, kv)
        den = torch.einsum("bhqf,bhf->bhq", phi_q, z)[..., None] + 1e-6
        o = num / den
        return (lambda x, *d: x.permute(*d))(o, 0, 2, 1, 3).reshape(B, S, D) @ wo

    def _B_ref(x, wqkv, wo):
        B, S, D = x.shape
        H = 32
        Dh = D // H
        qkv = (lambda x, *d: x.permute(*d))((x @ wqkv).reshape(B, S, 3, H, Dh), 2, 0, 3, 1, 4)
        q, k, v = qkv[0], qkv[1], qkv[2]
        scores = torch.einsum("bhqd,bhkd->bhqk", q, k) * (Dh ** -0.5)
        p = _softmax(scores, axis=-1)
        o = torch.einsum("bhqk,bhkd->bhqd", p, v)
        return (lambda x, *d: x.permute(*d))(o, 0, 2, 1, 3).reshape(B, S, D) @ wo

    x = A_x
    x = x + _A_ref(_layernorm(x, axis=-1), A_wqkv, A_w_phi, A_wo)
    x = x + _B_ref(_layernorm(x, axis=-1), B_wqkv, B_wo)
    x = x + _A_ref(_layernorm(x, axis=-1), A_wqkv, A_w_phi, A_wo)
    x = x + _B_ref(_layernorm(x, axis=-1), B_wqkv, B_wo)
    return x
```

```asm
; @launch grid=(256,1,1) block=(512,1,1) lds=163840
.amdgcn_target "amdgcn-amd-amdhsa--gfx950"
.text
.globl interleave_layers__linear_kernel_hedgehog__mha_block__prompt_kernel
.p2align 8
.type interleave_layers__linear_kernel_hedgehog__mha_block__prompt_kernel,@function
interleave_layers__linear_kernel_hedgehog__mha_block__prompt_kernel:
    s_cmp_ge_u32 s2, 256
    s_cbranch_scc1 interleave_layers__linear_kernel_hedgehog__mha_block__prompt_kernel_exit
    s_load_dwordx2 s[4:5], s[0:1], 72
    s_load_dwordx2 s[26:27], s[0:1], 8
    s_load_dwordx2 s[28:29], s[0:1], 40
    s_load_dwordx2 s[30:31], s[0:1], 24
    s_load_dwordx2 s[32:33], s[0:1], 48
    s_load_dwordx2 s[34:35], s[0:1], 16
    s_load_dwordx2 s[36:37], s[0:1], 56
    v_lshrrev_b32 v1, 6, v0
    v_and_b32 v255, 63, v0
    v_lshlrev_b32 v254, 4, v255
    s_and_b32 s38, s2, 7
    s_lshr_b32 s39, s2, 3
    v_readfirstlane_b32 s22, v1
    s_and_b32 s20, s38, 1
    s_lshl_b32 s20, s20, 3
    s_and_b32 s40, s39, 7
    s_add_u32 s20, s20, s40
    s_lshr_b32 s21, s38, 1
    s_lshl_b32 s21, s21, 2
    s_lshr_b32 s40, s39, 3
    s_add_u32 s21, s21, s40
    s_mov_b32 s25, 0
    s_mov_b32 s68, 0x3fb8aa3b
    s_load_dwordx2 s[74:75], s[0:1], 0
    s_waitcnt lgkmcnt(0)
    s_mov_b32 s8, s4
    s_and_b32 s9, s5, 0xffff
    s_mov_b32 s10, 0x10000000
    s_mov_b32 s11, 0x20000
    v_mov_b32 v217, 0
    s_mov_b32 s39, 0x3706800
    buffer_load_dword v218, v217, s[8:11], s39 offen sc1
    s_cmp_lt_u32 s22, 4
    s_cbranch_scc1 m_entry
    s_sub_u32 s23, s22, 4
l_layer:
    s_lshl_b32 s38, s25, 22
    s_mov_b32 s60, s38
    s_add_u32 s61, s60, 0x400000
    s_add_u32 s62, s38, 0x1000000
    s_lshl_b32 s38, s25, 18
    s_add_u32 s64, s38, 0x3500000
    s_add_u32 s65, s64, 0x40000
    s_lshr_b32 s39, s25, 1
    s_lshl_b32 s38, s39, 17
    s_add_u32 s67, s38, 0x3400000
    s_lshl_b32 s38, s39, 21
    s_add_u32 s38, s38, 0x3000000
    s_lshl_b32 s39, s39, 23
    s_add_u32 s39, s39, 0x2000000
    s_bitcmp1_b32 s25, 0
    s_cselect_b32 s63, s39, s38
    s_mul_i32 s38, s25, 0x1800
    s_add_u32 s66, s38, 0x3701800
    s_and_b32 s38, s25, 1
    s_mul_i32 s38, s38, 768
    s_add_u32 s70, s38, 132096
    s_bitcmp1_b32 s25, 0
    s_cselect_b32 s12, s28, s26
    s_cselect_b32 s13, s29, s27
    s_and_b32 s13, s13, 0xffff
    s_mov_b32 s14, 0x600000
    s_mov_b32 s15, 0x20000
    v_mov_b32 v2, v254
    v_lshrrev_b32 v5, 3, v255
    v_mul_u32_u24 v3, 6144, v5
    v_and_b32 v6, 7, v255
    v_bfe_u32 v7, v255, 4, 1
    v_lshlrev_b32 v7, 2, v7
    v_xor_b32 v6, v6, v7
    v_lshl_add_u32 v3, v6, 4, v3
    s_mul_i32 s59, s23, 98304
    s_lshl_b32 s39, s21, 7
    s_add_u32 s59, s59, s39
    s_and_b32 s56, s20, 1
    s_lshl_b32 s56, s56, 3
    s_mov_b32 s57, s56
    s_lshl_b32 s47, s23, 12
    s_lshl_b32 s48, s23, 11
    s_add_u32 s48, s48, 16384
    s_mov_b32 s45, 0
    s_mov_b32 s46, 0
    s_lshl_b32 s58, s20, 2
    s_add_u32 s58, s58, s23
    s_lshl_b32 s58, s58, 16
    s_cmp_eq_u32 s25, 0
    s_cbranch_scc1 l_xrow
    s_add_u32 s58, s58, s60
    s_mov_b32 s84, s4
    s_and_b32 s85, s5, 0xffff
    s_mov_b32 s86, 0x10000000
    s_mov_b32 s87, 0x20000
    s_mov_b32 s81, 1024
    s_mov_b32 s82, 4096
    v_mov_b32 v4, v254
    s_branch l_xdone
l_xrow:
    s_mov_b32 s84, s74
    s_and_b32 s85, s75, 0xffff
    s_mov_b32 s86, 0x400000
    s_mov_b32 s87, 0x20000
    s_mov_b32 s81, 16384
    s_mov_b32 s82, 128
    v_lshrrev_b32 v5, 3, v255
    v_lshlrev_b32 v5, 11, v5
    v_and_b32 v6, 7, v255
    v_lshrrev_b32 v7, 4, v255
    v_xor_b32 v6, v6, v7
    v_lshl_add_u32 v2, v6, 4, v5
    v_xor_b32 v4, 64, v2
l_xdone:
    s_cmp_eq_u32 s25, 0
    s_cbranch_scc0 l_w1
    s_cmp_lt_u32 s25, 2
    s_cbranch_scc0 l_nosh0
    s_mul_i32 s42, s20, 393216
    s_add_u32 s42, s42, s59
    s_lshl_b32 s44, s23, 11
    s_add_u32 m0, s44, 138240
    s_add_u32 s43, s42, 0
    buffer_load_dwordx4 v3, s[12:15], s43 offen lds
    s_add_u32 m0, s44, 139264
    s_add_u32 s43, s42, 49152
    buffer_load_dwordx4 v3, s[12:15], s43 offen lds
    s_add_u32 m0, s44, 146432
    s_add_u32 s43, s42, 2048
    buffer_load_dwordx4 v3, s[12:15], s43 offen lds
    s_add_u32 m0, s44, 147456
    s_add_u32 s43, s42, 51200
    buffer_load_dwordx4 v3, s[12:15], s43 offen lds
    s_add_u32 m0, s44, 155648
    s_add_u32 s43, s42, 4096
    buffer_load_dwordx4 v3, s[12:15], s43 offen lds
    s_add_u32 m0, s44, 156672
    s_add_u32 s43, s42, 53248
    buffer_load_dwordx4 v3, s[12:15], s43 offen lds
l_nosh0:
    s_mul_i32 s42, s57, 393216
    s_add_u32 s42, s42, s59
    s_add_u32 s57, s57, 1
    s_and_b32 s57, s57, 15
    s_add_u32 s44, s46, s48
    s_add_u32 m0, s44, 0
    s_add_u32 s43, s42, 0
    buffer_load_dwordx4 v3, s[12:15], s43 offen  lds
    s_add_u32 m0, s44, 1024
    s_add_u32 s43, s42, 49152
    buffer_load_dwordx4 v3, s[12:15], s43 offen  lds
    s_add_u32 m0, s44, 8192
    s_add_u32 s43, s42, 2048
    buffer_load_dwordx4 v3, s[12:15], s43 offen  lds
    s_add_u32 m0, s44, 9216
    s_add_u32 s43, s42, 51200
    buffer_load_dwordx4 v3, s[12:15], s43 offen  lds
    s_add_u32 m0, s44, 16384
    s_add_u32 s43, s42, 4096
    buffer_load_dwordx4 v3, s[12:15], s43 offen  lds
    s_add_u32 m0, s44, 17408
    s_add_u32 s43, s42, 53248
    buffer_load_dwordx4 v3, s[12:15], s43 offen  lds
    s_add_u32 s46, s46, 40960
    s_cmp_eq_u32 s46, 122880
    s_cselect_b32 s46, 0, s46
    s_mul_i32 s42, s57, 393216
    s_add_u32 s42, s42, s59
    s_add_u32 s57, s57, 1
    s_and_b32 s57, s57, 15
    s_add_u32 s44, s46, s48
    s_add_u32 m0, s44, 0
    s_add_u32 s43, s42, 0
    buffer_load_dwordx4 v3, s[12:15], s43 offen  lds
    s_add_u32 m0, s44, 1024
    s_add_u32 s43, s42, 49152
    buffer_load_dwordx4 v3, s[12:15], s43 offen  lds
    s_add_u32 m0, s44, 8192
    s_add_u32 s43, s42, 2048
    buffer_load_dwordx4 v3, s[12:15], s43 offen  lds
    s_add_u32 m0, s44, 9216
    s_add_u32 s43, s42, 51200
    buffer_load_dwordx4 v3, s[12:15], s43 offen  lds
    s_add_u32 m0, s44, 16384
    s_add_u32 s43, s42, 4096
    buffer_load_dwordx4 v3, s[12:15], s43 offen  lds
    s_add_u32 m0, s44, 17408
    s_add_u32 s43, s42, 53248
    buffer_load_dwordx4 v3, s[12:15], s43 offen  lds
    s_add_u32 s46, s46, 40960
    s_cmp_eq_u32 s46, 122880
    s_cselect_b32 s46, 0, s46
    s_mul_i32 s42, s57, 393216
    s_add_u32 s42, s42, s59
    s_add_u32 s57, s57, 1
    s_and_b32 s57, s57, 15
    s_add_u32 s44, s46, s48
    s_add_u32 m0, s44, 0
    s_add_u32 s43, s42, 0
    buffer_load_dwordx4 v3, s[12:15], s43 offen  lds
    s_add_u32 m0, s44, 1024
    s_add_u32 s43, s42, 49152
    buffer_load_dwordx4 v3, s[12:15], s43 offen  lds
    s_add_u32 m0, s44, 8192
    s_add_u32 s43, s42, 2048
    buffer_load_dwordx4 v3, s[12:15], s43 offen  lds
    s_add_u32 m0, s44, 9216
    s_add_u32 s43, s42, 51200
    buffer_load_dwordx4 v3, s[12:15], s43 offen  lds
    s_add_u32 m0, s44, 16384
    s_add_u32 s43, s42, 4096
    buffer_load_dwordx4 v3, s[12:15], s43 offen  lds
    s_add_u32 m0, s44, 17408
    s_add_u32 s43, s42, 53248
    buffer_load_dwordx4 v3, s[12:15], s43 offen  lds
    s_add_u32 s46, s46, 40960
    s_cmp_eq_u32 s46, 122880
    s_cselect_b32 s46, 0, s46
    s_mul_i32 s41, s56, s82
    s_add_u32 s41, s41, s58
    s_add_u32 s43, s45, s47
    s_add_u32 s56, s56, 1
    s_and_b32 s56, s56, 15
    s_add_u32 m0, s43, 0
    s_nop 0
    buffer_load_dwordx4 v2, s[84:87], s41 offen sc1 lds
    s_add_u32 m0, s43, 1024
    s_add_u32 s41, s41, s81
    buffer_load_dwordx4 v4, s[84:87], s41 offen sc1 lds
    s_add_u32 m0, s43, 2048
    s_add_u32 s41, s41, s81
    buffer_load_dwordx4 v2, s[84:87], s41 offen sc1 lds
    s_add_u32 m0, s43, 3072
    s_add_u32 s41, s41, s81
    buffer_load_dwordx4 v4, s[84:87], s41 offen sc1 lds
    s_add_u32 s45, s45, 40960
    s_cmp_eq_u32 s45, 122880
    s_cselect_b32 s45, 0, s45
    s_mov_b32 s16, s34
    s_and_b32 s17, s35, 0xffff
    s_mov_b32 s18, 0x10000
    s_mov_b32 s19, 0x20000
    s_lshl_b32 s49, s21, 12
    s_lshl_b32 s39, s23, 10
    s_add_u32 s49, s49, s39
    s_add_u32 m0, s39, 134144
    s_nop 0
    buffer_load_dwordx4 v254, s[16:19], s49 offen lds
    s_mul_i32 s41, s56, s82
    s_add_u32 s41, s41, s58
    s_add_u32 s43, s45, s47
    s_add_u32 s56, s56, 1
    s_and_b32 s56, s56, 15
    s_add_u32 m0, s43, 0
    s_nop 0
    buffer_load_dwordx4 v2, s[84:87], s41 offen sc1 lds
    s_add_u32 m0, s43, 1024
    s_add_u32 s41, s41, s81
    buffer_load_dwordx4 v4, s[84:87], s41 offen sc1 lds
    s_add_u32 m0, s43, 2048
    s_add_u32 s41, s41, s81
    buffer_load_dwordx4 v2, s[84:87], s41 offen sc1 lds
    s_add_u32 m0, s43, 3072
    s_add_u32 s41, s41, s81
    buffer_load_dwordx4 v4, s[84:87], s41 offen sc1 lds
    s_add_u32 s45, s45, 40960
    s_cmp_eq_u32 s45, 122880
    s_cselect_b32 s45, 0, s45
    s_mul_i32 s41, s56, s82
    s_add_u32 s41, s41, s58
    s_add_u32 s43, s45, s47
    s_add_u32 s56, s56, 1
    s_and_b32 s56, s56, 15
    s_add_u32 m0, s43, 0
    s_nop 0
    buffer_load_dwordx4 v2, s[84:87], s41 offen sc1 lds
    s_add_u32 m0, s43, 1024
    s_add_u32 s41, s41, s81
    buffer_load_dwordx4 v4, s[84:87], s41 offen sc1 lds
    s_add_u32 m0, s43, 2048
    s_add_u32 s41, s41, s81
    buffer_load_dwordx4 v2, s[84:87], s41 offen sc1 lds
    s_add_u32 m0, s43, 3072
    s_add_u32 s41, s41, s81
    buffer_load_dwordx4 v4, s[84:87], s41 offen sc1 lds
    s_add_u32 s45, s45, 40960
    s_cmp_eq_u32 s45, 122880
    s_cselect_b32 s45, 0, s45
    s_waitcnt vmcnt(31)
    s_barrier
    s_branch l_w2
l_w1:
    s_cmp_lt_u32 s25, 2
    s_cbranch_scc0 l_nosh1
    s_mul_i32 s42, s20, 393216
    s_add_u32 s42, s42, s59
    s_lshl_b32 s44, s23, 11
    s_add_u32 m0, s44, 138240
    s_add_u32 s43, s42, 0
    buffer_load_dwordx4 v3, s[12:15], s43 offen lds
    s_add_u32 m0, s44, 139264
    s_add_u32 s43, s42, 49152
    buffer_load_dwordx4 v3, s[12:15], s43 offen lds
    s_add_u32 m0, s44, 146432
    s_add_u32 s43, s42, 2048
    buffer_load_dwordx4 v3, s[12:15], s43 offen lds
    s_add_u32 m0, s44, 147456
    s_add_u32 s43, s42, 51200
    buffer_load_dwordx4 v3, s[12:15], s43 offen lds
    s_add_u32 m0, s44, 155648
    s_add_u32 s43, s42, 4096
    buffer_load_dwordx4 v3, s[12:15], s43 offen lds
    s_add_u32 m0, s44, 156672
    s_add_u32 s43, s42, 53248
    buffer_load_dwordx4 v3, s[12:15], s43 offen lds
l_nosh1:
    s_barrier
    s_mul_i32 s42, s57, 393216
    s_add_u32 s42, s42, s59
    s_add_u32 s57, s57, 1
    s_and_b32 s57, s57, 15
    s_add_u32 s44, s46, s48
    s_add_u32 m0, s44, 0
    s_add_u32 s43, s42, 0
    buffer_load_dwordx4 v3, s[12:15], s43 offen  lds
    s_add_u32 m0, s44, 1024
    s_add_u32 s43, s42, 49152
    buffer_load_dwordx4 v3, s[12:15], s43 offen  lds
    s_add_u32 m0, s44, 8192
    s_add_u32 s43, s42, 2048
    buffer_load_dwordx4 v3, s[12:15], s43 offen  lds
    s_add_u32 m0, s44, 9216
    s_add_u32 s43, s42, 51200
    buffer_load_dwordx4 v3, s[12:15], s43 offen  lds
    s_add_u32 m0, s44, 16384
    s_add_u32 s43, s42, 4096
    buffer_load_dwordx4 v3, s[12:15], s43 offen  lds
    s_add_u32 m0, s44, 17408
    s_add_u32 s43, s42, 53248
    buffer_load_dwordx4 v3, s[12:15], s43 offen  lds
    s_add_u32 s46, s46, 40960
    s_cmp_eq_u32 s46, 122880
    s_cselect_b32 s46, 0, s46
    s_mul_i32 s42, s57, 393216
    s_add_u32 s42, s42, s59
    s_add_u32 s57, s57, 1
    s_and_b32 s57, s57, 15
    s_add_u32 s44, s46, s48
    s_add_u32 m0, s44, 0
    s_add_u32 s43, s42, 0
    buffer_load_dwordx4 v3, s[12:15], s43 offen  lds
    s_add_u32 m0, s44, 1024
    s_add_u32 s43, s42, 49152
    buffer_load_dwordx4 v3, s[12:15], s43 offen  lds
    s_add_u32 m0, s44, 8192
    s_add_u32 s43, s42, 2048
    buffer_load_dwordx4 v3, s[12:15], s43 offen  lds
    s_add_u32 m0, s44, 9216
    s_add_u32 s43, s42, 51200
    buffer_load_dwordx4 v3, s[12:15], s43 offen  lds
    s_add_u32 m0, s44, 16384
    s_add_u32 s43, s42, 4096
    buffer_load_dwordx4 v3, s[12:15], s43 offen  lds
    s_add_u32 m0, s44, 17408
    s_add_u32 s43, s42, 53248
    buffer_load_dwordx4 v3, s[12:15], s43 offen  lds
    s_add_u32 s46, s46, 40960
    s_cmp_eq_u32 s46, 122880
    s_cselect_b32 s46, 0, s46
    s_mul_i32 s42, s57, 393216
    s_add_u32 s42, s42, s59
    s_add_u32 s57, s57, 1
    s_and_b32 s57, s57, 15
    s_add_u32 s44, s46, s48
    s_add_u32 m0, s44, 0
    s_add_u32 s43, s42, 0
    buffer_load_dwordx4 v3, s[12:15], s43 offen  lds
    s_add_u32 m0, s44, 1024
    s_add_u32 s43, s42, 49152
    buffer_load_dwordx4 v3, s[12:15], s43 offen  lds
    s_add_u32 m0, s44, 8192
    s_add_u32 s43, s42, 2048
    buffer_load_dwordx4 v3, s[12:15], s43 offen  lds
    s_add_u32 m0, s44, 9216
    s_add_u32 s43, s42, 51200
    buffer_load_dwordx4 v3, s[12:15], s43 offen  lds
    s_add_u32 m0, s44, 16384
    s_add_u32 s43, s42, 4096
    buffer_load_dwordx4 v3, s[12:15], s43 offen  lds
    s_add_u32 m0, s44, 17408
    s_add_u32 s43, s42, 53248
    buffer_load_dwordx4 v3, s[12:15], s43 offen  lds
    s_add_u32 s46, s46, 40960
    s_cmp_eq_u32 s46, 122880
    s_cselect_b32 s46, 0, s46
    s_waitcnt vmcnt(18)
    s_barrier
    s_mul_i32 s41, s56, s82
    s_add_u32 s41, s41, s58
    s_add_u32 s43, s45, s47
    s_add_u32 s56, s56, 1
    s_and_b32 s56, s56, 15
    s_add_u32 m0, s43, 0
    s_nop 0
    buffer_load_dwordx4 v2, s[84:87], s41 offen sc1 lds
    s_add_u32 m0, s43, 1024
    s_add_u32 s41, s41, s81
    buffer_load_dwordx4 v4, s[84:87], s41 offen sc1 lds
    s_add_u32 m0, s43, 2048
    s_add_u32 s41, s41, s81
    buffer_load_dwordx4 v2, s[84:87], s41 offen sc1 lds
    s_add_u32 m0, s43, 3072
    s_add_u32 s41, s41, s81
    buffer_load_dwordx4 v4, s[84:87], s41 offen sc1 lds
    s_add_u32 s45, s45, 40960
    s_cmp_eq_u32 s45, 122880
    s_cselect_b32 s45, 0, s45
    s_mov_b32 s16, s34
    s_and_b32 s17, s35, 0xffff
    s_mov_b32 s18, 0x10000
    s_mov_b32 s19, 0x20000
    s_lshl_b32 s49, s21, 12
    s_lshl_b32 s39, s23, 10
    s_add_u32 s49, s49, s39
    s_add_u32 m0, s39, 134144
    s_nop 0
    buffer_load_dwordx4 v254, s[16:19], s49 offen lds
    s_mul_i32 s41, s56, s82
    s_add_u32 s41, s41, s58
    s_add_u32 s43, s45, s47
    s_add_u32 s56, s56, 1
    s_and_b32 s56, s56, 15
    s_add_u32 m0, s43, 0
    s_nop 0
    buffer_load_dwordx4 v2, s[84:87], s41 offen sc1 lds
    s_add_u32 m0, s43, 1024
    s_add_u32 s41, s41, s81
    buffer_load_dwordx4 v4, s[84:87], s41 offen sc1 lds
    s_add_u32 m0, s43, 2048
    s_add_u32 s41, s41, s81
    buffer_load_dwordx4 v2, s[84:87], s41 offen sc1 lds
    s_add_u32 m0, s43, 3072
    s_add_u32 s41, s41, s81
    buffer_load_dwordx4 v4, s[84:87], s41 offen sc1 lds
    s_add_u32 s45, s45, 40960
    s_cmp_eq_u32 s45, 122880
    s_cselect_b32 s45, 0, s45
    s_mul_i32 s41, s56, s82
    s_add_u32 s41, s41, s58
    s_add_u32 s43, s45, s47
    s_add_u32 s56, s56, 1
    s_and_b32 s56, s56, 15
    s_add_u32 m0, s43, 0
    s_nop 0
    buffer_load_dwordx4 v2, s[84:87], s41 offen sc1 lds
    s_add_u32 m0, s43, 1024
    s_add_u32 s41, s41, s81
    buffer_load_dwordx4 v4, s[84:87], s41 offen sc1 lds
    s_add_u32 m0, s43, 2048
    s_add_u32 s41, s41, s81
    buffer_load_dwordx4 v2, s[84:87], s41 offen sc1 lds
    s_add_u32 m0, s43, 3072
    s_add_u32 s41, s41, s81
    buffer_load_dwordx4 v4, s[84:87], s41 offen sc1 lds
    s_add_u32 s45, s45, 40960
    s_cmp_eq_u32 s45, 122880
    s_cselect_b32 s45, 0, s45
l_w2:
    s_waitcnt vmcnt(9)
    v_readfirstlane_b32 s80, v218
    s_barrier
    s_add_u32 s69, s80, 1
    s_waitcnt vmcnt(4)
    s_barrier
    s_mul_i32 s41, s56, s82
    s_add_u32 s41, s41, s58
    s_add_u32 s43, s45, s47
    s_add_u32 s56, s56, 1
    s_and_b32 s56, s56, 15
    s_add_u32 m0, s43, 0
    s_nop 0
    buffer_load_dwordx4 v2, s[84:87], s41 offen sc1 lds
    s_add_u32 m0, s43, 1024
    s_add_u32 s41, s41, s81
    buffer_load_dwordx4 v4, s[84:87], s41 offen sc1 lds
    s_add_u32 m0, s43, 2048
    s_add_u32 s41, s41, s81
    buffer_load_dwordx4 v2, s[84:87], s41 offen sc1 lds
    s_add_u32 m0, s43, 3072
    s_add_u32 s41, s41, s81
    buffer_load_dwordx4 v4, s[84:87], s41 offen sc1 lds
    s_add_u32 s45, s45, 40960
    s_cmp_eq_u32 s45, 122880
    s_cselect_b32 s45, 0, s45
    s_mul_i32 s42, s57, 393216
    s_add_u32 s42, s42, s59
    s_add_u32 s57, s57, 1
    s_and_b32 s57, s57, 15
    s_add_u32 s44, s46, s48
    s_add_u32 m0, s44, 0
    s_add_u32 s43, s42, 0
    buffer_load_dwordx4 v3, s[12:15], s43 offen  lds
    s_add_u32 m0, s44, 1024
    s_add_u32 s43, s42, 49152
    buffer_load_dwordx4 v3, s[12:15], s43 offen  lds
    s_add_u32 m0, s44, 8192
    s_add_u32 s43, s42, 2048
    buffer_load_dwordx4 v3, s[12:15], s43 offen  lds
    s_add_u32 m0, s44, 9216
    s_add_u32 s43, s42, 51200
    buffer_load_dwordx4 v3, s[12:15], s43 offen  lds
    s_add_u32 m0, s44, 16384
    s_add_u32 s43, s42, 4096
    buffer_load_dwordx4 v3, s[12:15], s43 offen  lds
    s_add_u32 m0, s44, 17408
    s_add_u32 s43, s42, 53248
    buffer_load_dwordx4 v3, s[12:15], s43 offen  lds
    s_add_u32 s46, s46, 40960
    s_cmp_eq_u32 s46, 122880
    s_cselect_b32 s46, 0, s46
    s_cmp_lt_u32 s25, 2
    s_cbranch_scc0 l_nopub
    s_cmp_eq_u32 s23, 3
    s_cbranch_scc0 l_nopub
    v_lshlrev_b32 v5, 3, v255
    v_add_u32 v6, 138240, v5
    ds_read_b64 v[16:17], v6 offset:0
    ds_read_b64 v[18:19], v6 offset:512
    ds_read_b64 v[20:21], v6 offset:2048
    ds_read_b64 v[22:23], v6 offset:2560
    ds_read_b64 v[24:25], v6 offset:4096
    ds_read_b64 v[26:27], v6 offset:4608
    ds_read_b64 v[28:29], v6 offset:6144
    ds_read_b64 v[30:31], v6 offset:6656
    s_and_b32 s39, s25, 1
    s_mul_i32 s39, s39, 196608
    s_mul_i32 s43, s20, 12288
    s_add_u32 s43, s43, s39
    s_lshl_b32 s44, s21, 8
    s_add_u32 s43, s43, s44
    s_add_u32 s43, s43, 0x3600000
    v_lshrrev_b32 v8, 5, v255
    v_and_b32 v9, 31, v255
    v_lshlrev_b32 v9, 3, v9
    v_lshl_add_u32 v8, v8, 12, v9
    v_add_u32 v9, 8192, v9
    s_waitcnt lgkmcnt(0)
    v_add_f32 v16, v16, v20
    v_add_f32 v17, v17, v21
    v_add_f32 v18, v18, v22
    v_add_f32 v19, v19, v23
    v_add_f32 v16, v16, v24
    v_add_f32 v17, v17, v25
    v_add_f32 v18, v18, v26
    v_add_f32 v19, v19, v27
    v_add_f32 v16, v16, v28
    v_add_f32 v17, v17, v29
    v_add_f32 v18, v18, v30
    v_add_f32 v19, v19, v31
    buffer_store_dwordx2 v[16:17], v8, s[8:11], s43 offen sc1
    s_mov_b64 exec, 0xffffffff
    buffer_store_dwordx2 v[18:19], v9, s[8:11], s43 offen sc1
    s_mov_b64 exec, -1
l_nopub:
    s_mov_b32 s49, 12
l_loop:
    s_waitcnt vmcnt(10)
    s_barrier
    s_cmp_eq_u32 s49, 11
    s_cbranch_scc0 l_nosig
    s_cmp_lt_u32 s25, 2
    s_cbranch_scc0 l_nosig
    s_cmp_eq_u32 s23, 3
    s_cbranch_scc0 l_nosig
    s_and_b32 s38, s25, 1
    s_mul_i32 s38, s38, 2048
    s_lshl_b32 s39, s21, 7
    s_add_u32 s38, s38, s39
    s_add_u32 s38, s38, 0x3700000
    s_lshl_b32 s39, s20, 3
    v_mov_b32 v250, s39
    v_mov_b32 v248, s69
    v_not_b32 v249, v248
    s_mov_b64 exec, 1
    buffer_store_dwordx2 v[248:249], v250, s[8:11], s38 offen sc1
    s_mov_b64 exec, -1
l_nosig:
    s_mul_i32 s41, s56, s82
    s_add_u32 s41, s41, s58
    s_add_u32 s43, s45, s47
    s_add_u32 s56, s56, 1
    s_and_b32 s56, s56, 15
    s_add_u32 m0, s43, 0
    s_nop 0
    buffer_load_dwordx4 v2, s[84:87], s41 offen sc1 lds
    s_add_u32 m0, s43, 1024
    s_add_u32 s41, s41, s81
    buffer_load_dwordx4 v4, s[84:87], s41 offen sc1 lds
    s_add_u32 m0, s43, 2048
    s_add_u32 s41, s41, s81
    buffer_load_dwordx4 v2, s[84:87], s41 offen sc1 lds
    s_add_u32 m0, s43, 3072
    s_add_u32 s41, s41, s81
    buffer_load_dwordx4 v4, s[84:87], s41 offen sc1 lds
    s_add_u32 s45, s45, 40960
    s_cmp_eq_u32 s45, 122880
    s_cselect_b32 s45, 0, s45
    s_mul_i32 s42, s57, 393216
    s_add_u32 s42, s42, s59
    s_add_u32 s57, s57, 1
    s_and_b32 s57, s57, 15
    s_add_u32 s44, s46, s48
    s_add_u32 m0, s44, 0
    s_add_u32 s43, s42, 0
    buffer_load_dwordx4 v3, s[12:15], s43 offen  lds
    s_add_u32 m0, s44, 1024
    s_add_u32 s43, s42, 49152
    buffer_load_dwordx4 v3, s[12:15], s43 offen  lds
    s_add_u32 m0, s44, 8192
    s_add_u32 s43, s42, 2048
    buffer_load_dwordx4 v3, s[12:15], s43 offen  lds
    s_add_u32 m0, s44, 9216
    s_add_u32 s43, s42, 51200
    buffer_load_dwordx4 v3, s[12:15], s43 offen  lds
    s_add_u32 m0, s44, 16384
    s_add_u32 s43, s42, 4096
    buffer_load_dwordx4 v3, s[12:15], s43 offen  lds
    s_add_u32 m0, s44, 17408
    s_add_u32 s43, s42, 53248
    buffer_load_dwordx4 v3, s[12:15], s43 offen  lds
    s_add_u32 s46, s46, 40960
    s_cmp_eq_u32 s46, 122880
    s_cselect_b32 s46, 0, s46
    s_sub_u32 s49, s49, 1
    s_cmp_lg_u32 s49, 0
    s_cbranch_scc1 l_loop
    s_cmp_ge_u32 s23, 2
    s_cbranch_scc1 l_colf
    s_lshl_b32 s38, s20, 7
    s_add_u32 s38, s38, s66
    s_sub_u32 s38, s38, 2048
    s_branch l_stf
l_colf:
    s_and_b32 s38, s25, 1
    s_mul_i32 s38, s38, 2048
    s_lshl_b32 s39, s21, 7
    s_add_u32 s38, s38, s39
    s_add_u32 s38, s38, 0x3700000
l_stf:
    v_and_b32 v250, 15, v255
    v_lshlrev_b32 v250, 3, v250
    buffer_load_dwordx2 v[248:249], v250, s[8:11], s38 offen sc1
    s_waitcnt vmcnt(11)
    s_barrier
    s_waitcnt vmcnt(0)
    s_not_b32 s71, s69
    v_cmp_eq_u32 vcc, s69, v248
    v_cmp_eq_u32 s[72:73], s71, v249
    s_nop 0
    s_and_b64 vcc, vcc, s[72:73]
    s_cmp_eq_u64 vcc, exec
    s_cbranch_scc1 l_colok
    v_and_b32 v250, 15, v255
    v_lshlrev_b32 v250, 3, v250
    s_mov_b32 s39, 65536
    s_not_b32 s71, s69
    buffer_load_dwordx2 v[248:249], v250, s[8:11], s38 offen sc1
poll2:
    s_waitcnt vmcnt(0)
    v_cmp_eq_u32 vcc, s69, v248
    v_cmp_eq_u32 s[72:73], s71, v249
    s_nop 0
    s_and_b64 vcc, vcc, s[72:73]
    s_cmp_eq_u64 vcc, exec
    s_cbranch_scc1 poll2_done
    buffer_load_dwordx2 v[248:249], v250, s[8:11], s38 offen sc1
    s_sub_u32 s39, s39, 1
    s_cmp_lg_u32 s39, 0
    s_cbranch_scc1 poll2
poll2_done:
l_colok:
    s_cmp_ge_u32 s23, 2
    s_cbranch_scc1 l_cola
    s_lshl_b32 s49, s20, 7
    s_lshl_b32 s39, s23, 6
    s_add_u32 s49, s49, s39
    s_lshl_b32 s49, s49, 3
    s_add_u32 s49, s49, s64
    s_mov_b32 s50, 16384
    v_lshlrev_b32 v5, 3, v255
    s_branch l_stl
l_cola:
    s_sub_u32 s49, s23, 2
    s_lshl_b32 s49, s49, 1
    v_lshrrev_b32 v5, 5, v255
    v_add_u32 v5, s49, v5
    v_min_u32 v5, 2, v5
    v_and_b32 v6, 31, v255
    v_lshlrev_b32 v6, 3, v6
    v_lshl_add_u32 v7, v5, 8, v6
    v_lshl_add_u32 v5, v5, 12, v6
    s_and_b32 s39, s25, 1
    s_mul_i32 s39, s39, 196608
    s_lshl_b32 s49, s21, 8
    s_add_u32 s49, s49, s39
    s_add_u32 s49, s49, 0x3600000
    s_mov_b32 s50, 12288
l_stl:
    buffer_load_dwordx2 v[16:17], v5, s[8:11], s49 offen sc1
    s_add_u32 s49, s49, s50
    buffer_load_dwordx2 v[18:19], v5, s[8:11], s49 offen sc1
    s_add_u32 s49, s49, s50
    buffer_load_dwordx2 v[20:21], v5, s[8:11], s49 offen sc1
    s_add_u32 s49, s49, s50
    buffer_load_dwordx2 v[22:23], v5, s[8:11], s49 offen sc1
    s_add_u32 s49, s49, s50
    buffer_load_dwordx2 v[24:25], v5, s[8:11], s49 offen sc1
    s_add_u32 s49, s49, s50
    buffer_load_dwordx2 v[26:27], v5, s[8:11], s49 offen sc1
    s_add_u32 s49, s49, s50
    buffer_load_dwordx2 v[28:29], v5, s[8:11], s49 offen sc1
    s_add_u32 s49, s49, s50
    buffer_load_dwordx2 v[30:31], v5, s[8:11], s49 offen sc1
    s_add_u32 s49, s49, s50
    buffer_load_dwordx2 v[32:33], v5, s[8:11], s49 offen sc1
    s_add_u32 s49, s49, s50
    buffer_load_dwordx2 v[34:35], v5, s[8:11], s49 offen sc1
    s_add_u32 s49, s49, s50
    buffer_load_dwordx2 v[36:37], v5, s[8:11], s49 offen sc1
    s_add_u32 s49, s49, s50
    buffer_load_dwordx2 v[38:39], v5, s[8:11], s49 offen sc1
    s_add_u32 s49, s49, s50
    buffer_load_dwordx2 v[40:41], v5, s[8:11], s49 offen sc1
    s_add_u32 s49, s49, s50
    buffer_load_dwordx2 v[42:43], v5, s[8:11], s49 offen sc1
    s_add_u32 s49, s49, s50
    buffer_load_dwordx2 v[44:45], v5, s[8:11], s49 offen sc1
    s_add_u32 s49, s49, s50
    buffer_load_dwordx2 v[46:47], v5, s[8:11], s49 offen sc1
    s_barrier
    s_waitcnt vmcnt(0)
    v_add_f32 v16, v16, v18
    v_add_f32 v17, v17, v19
    v_add_f32 v16, v16, v20
    v_add_f32 v17, v17, v21
    v_add_f32 v16, v16, v22
    v_add_f32 v17, v17, v23
    v_add_f32 v16, v16, v24
    v_add_f32 v17, v17, v25
    v_add_f32 v16, v16, v26
    v_add_f32 v17, v17, v27
    v_add_f32 v16, v16, v28
    v_add_f32 v17, v17, v29
    v_add_f32 v16, v16, v30
    v_add_f32 v17, v17, v31
    v_add_f32 v16, v16, v32
    v_add_f32 v17, v17, v33
    v_add_f32 v16, v16, v34
    v_add_f32 v17, v17, v35
    v_add_f32 v16, v16, v36
    v_add_f32 v17, v17, v37
    v_add_f32 v16, v16, v38
    v_add_f32 v17, v17, v39
    v_add_f32 v16, v16, v40
    v_add_f32 v17, v17, v41
    v_add_f32 v16, v16, v42
    v_add_f32 v17, v17, v43
    v_add_f32 v16, v16, v44
    v_add_f32 v17, v17, v45
    v_add_f32 v16, v16, v46
    v_add_f32 v17, v17, v47
    s_cmp_ge_u32 s23, 2
    s_cbranch_scc1 l_colw
    v_mul_f32 v16, 0x3a800000, v16
    v_mul_f32 v17, 0x3a800000, v17
    v_fma_f32 v17, -v16, v16, v17
    v_max_f32 v17, 0, v17
    v_add_f32 v17, 0x3727c5ac, v17
    v_rsq_f32 v17, v17
    v_sub_f32 v16, 0, v16
    s_lshl_b32 s39, s23, 8
    v_lshlrev_b32 v5, 2, v255
    v_add_u32 v5, s39, v5
    v_add_u32 v5, 131072, v5
    ds_write_b32 v5, v16
    ds_write_b32 v5, v17 offset:512
    s_branch l_stw
l_colw:
    v_add_u32 v7, s70, v7
    ds_write_b64 v7, v[16:17]
l_stw:
    s_waitcnt lgkmcnt(0)
l_cole:
    s_barrier
    s_bitcmp1_b32 s25, 0
    s_cbranch_scc1 l_B
    s_bitcmp1_b32 s25, 0
    s_cselect_b32 s12, s32, s30
    s_cselect_b32 s13, s33, s31
    s_and_b32 s13, s13, 0xffff
    s_mov_b32 s14, 0x200000
    s_mov_b32 s15, 0x20000
    s_lshl_b32 s41, s23, 5
    v_lshrrev_b32 v5, 3, v255
    v_lshlrev_b32 v6, 11, v5
    v_and_b32 v5, 7, v255
    v_bfe_u32 v7, v255, 4, 1
    v_lshlrev_b32 v7, 2, v7
    v_xor_b32 v5, v5, v7
    v_lshl_add_u32 v5, v5, 4, v6
    s_lshl_b32 s43, s41, 14
    s_lshl_b32 s44, s21, 7
    s_add_u32 s43, s43, s44
    s_lshl_b32 s44, s41, 10
    s_mov_b32 m0, s44
    s_add_u32 s44, s44, 1024
    buffer_load_dwordx4 v5, s[12:15], s43 offen  lds
    s_add_u32 s43, s43, 16384
    s_mov_b32 m0, s44
    s_add_u32 s44, s44, 1024
    buffer_load_dwordx4 v5, s[12:15], s43 offen  lds
    s_add_u32 s43, s43, 16384
    s_mov_b32 m0, s44
    s_add_u32 s44, s44, 1024
    buffer_load_dwordx4 v5, s[12:15], s43 offen  lds
    s_add_u32 s43, s43, 16384
    s_mov_b32 m0, s44
    s_add_u32 s44, s44, 1024
    buffer_load_dwordx4 v5, s[12:15], s43 offen  lds
    s_add_u32 s43, s43, 16384
    s_mov_b32 m0, s44
    s_add_u32 s44, s44, 1024
    buffer_load_dwordx4 v5, s[12:15], s43 offen  lds
    s_add_u32 s43, s43, 16384
    s_mov_b32 m0, s44
    s_add_u32 s44, s44, 1024
    buffer_load_dwordx4 v5, s[12:15], s43 offen  lds
    s_add_u32 s43, s43, 16384
    s_mov_b32 m0, s44
    s_add_u32 s44, s44, 1024
    buffer_load_dwordx4 v5, s[12:15], s43 offen  lds
    s_add_u32 s43, s43, 16384
    s_mov_b32 m0, s44
    s_add_u32 s44, s44, 1024
    buffer_load_dwordx4 v5, s[12:15], s43 offen  lds
    s_add_u32 s43, s43, 16384
    s_mov_b32 m0, s44
    s_add_u32 s44, s44, 1024
    buffer_load_dwordx4 v5, s[12:15], s43 offen  lds
    s_add_u32 s43, s43, 16384
    s_mov_b32 m0, s44
    s_add_u32 s44, s44, 1024
    buffer_load_dwordx4 v5, s[12:15], s43 offen  lds
    s_add_u32 s43, s43, 16384
    s_mov_b32 m0, s44
    s_add_u32 s44, s44, 1024
    buffer_load_dwordx4 v5, s[12:15], s43 offen  lds
    s_add_u32 s43, s43, 16384
    s_mov_b32 m0, s44
    s_add_u32 s44, s44, 1024
    buffer_load_dwordx4 v5, s[12:15], s43 offen  lds
    s_add_u32 s43, s43, 16384
    s_mov_b32 m0, s44
    s_add_u32 s44, s44, 1024
    buffer_load_dwordx4 v5, s[12:15], s43 offen  lds
    s_add_u32 s43, s43, 16384
    s_mov_b32 m0, s44
    s_add_u32 s44, s44, 1024
    buffer_load_dwordx4 v5, s[12:15], s43 offen  lds
    s_add_u32 s43, s43, 16384
    s_mov_b32 m0, s44
    s_add_u32 s44, s44, 1024
    buffer_load_dwordx4 v5, s[12:15], s43 offen  lds
    s_add_u32 s43, s43, 16384
    s_mov_b32 m0, s44
    s_add_u32 s44, s44, 1024
    buffer_load_dwordx4 v5, s[12:15], s43 offen  lds
    s_add_u32 s43, s43, 16384
    s_mov_b32 m0, s44
    s_add_u32 s44, s44, 1024
    buffer_load_dwordx4 v5, s[12:15], s43 offen  lds
    s_add_u32 s43, s43, 16384
    s_mov_b32 m0, s44
    s_add_u32 s44, s44, 1024
    buffer_load_dwordx4 v5, s[12:15], s43 offen  lds
    s_add_u32 s43, s43, 16384
    s_mov_b32 m0, s44
    s_add_u32 s44, s44, 1024
    buffer_load_dwordx4 v5, s[12:15], s43 offen  lds
    s_add_u32 s43, s43, 16384
    s_mov_b32 m0, s44
    s_add_u32 s44, s44, 1024
    buffer_load_dwordx4 v5, s[12:15], s43 offen  lds
    s_add_u32 s43, s43, 16384
    s_mov_b32 m0, s44
    s_add_u32 s44, s44, 1024
    buffer_load_dwordx4 v5, s[12:15], s43 offen  lds
    s_add_u32 s43, s43, 16384
    s_mov_b32 m0, s44
    s_add_u32 s44, s44, 1024
    buffer_load_dwordx4 v5, s[12:15], s43 offen  lds
    s_add_u32 s43, s43, 16384
    s_mov_b32 m0, s44
    s_add_u32 s44, s44, 1024
    buffer_load_dwordx4 v5, s[12:15], s43 offen  lds
    s_add_u32 s43, s43, 16384
    s_mov_b32 m0, s44
    s_add_u32 s44, s44, 1024
    buffer_load_dwordx4 v5, s[12:15], s43 offen  lds
    s_add_u32 s43, s43, 16384
    s_mov_b32 m0, s44
    s_add_u32 s44, s44, 1024
    buffer_load_dwordx4 v5, s[12:15], s43 offen  lds
    s_add_u32 s43, s43, 16384
    s_mov_b32 m0, s44
    s_add_u32 s44, s44, 1024
    buffer_load_dwordx4 v5, s[12:15], s43 offen  lds
    s_add_u32 s43, s43, 16384
    s_mov_b32 m0, s44
    s_add_u32 s44, s44, 1024
    buffer_load_dwordx4 v5, s[12:15], s43 offen  lds
    s_add_u32 s43, s43, 16384
    s_mov_b32 m0, s44
    s_add_u32 s44, s44, 1024
    buffer_load_dwordx4 v5, s[12:15], s43 offen  lds
    s_add_u32 s43, s43, 16384
    s_mov_b32 m0, s44
    s_add_u32 s44, s44, 1024
    buffer_load_dwordx4 v5, s[12:15], s43 offen  lds
    s_add_u32 s43, s43, 16384
    s_mov_b32 m0, s44
    s_add_u32 s44, s44, 1024
    buffer_load_dwordx4 v5, s[12:15], s43 offen  lds
    s_add_u32 s43, s43, 16384
    s_mov_b32 m0, s44
    s_add_u32 s44, s44, 1024
    buffer_load_dwordx4 v5, s[12:15], s43 offen  lds
    s_add_u32 s43, s43, 16384
    s_mov_b32 m0, s44
    s_add_u32 s44, s44, 1024
    buffer_load_dwordx4 v5, s[12:15], s43 offen  lds
    s_barrier
    s_barrier
    s_cmp_eq_u32 s22, 4
    s_cbranch_scc0 l_hkv
    s_lshl_b32 s38, s21, 7
    s_add_u32 s38, s38, s66
    s_lshl_b32 s39, s20, 3
    v_mov_b32 v250, s39
    v_mov_b32 v248, s69
    v_not_b32 v249, v248
    s_mov_b64 exec, 1
    buffer_store_dwordx2 v[248:249], v250, s[8:11], s38 offen sc1
    s_mov_b64 exec, -1
    v_and_b32 v250, 15, v255
    v_lshlrev_b32 v250, 3, v250
    s_mov_b32 s39, 65536
    s_not_b32 s71, s69
    buffer_load_dwordx2 v[248:249], v250, s[8:11], s38 offen sc1
poll3:
    s_waitcnt vmcnt(0)
    v_cmp_eq_u32 vcc, s69, v248
    v_cmp_eq_u32 s[72:73], s71, v249
    s_nop 0
    s_and_b64 vcc, vcc, s[72:73]
    s_cmp_eq_u64 vcc, exec
    s_cbranch_scc1 poll3_done
    buffer_load_dwordx2 v[248:249], v250, s[8:11], s38 offen sc1
    s_sub_u32 s39, s39, 1
    s_cmp_lg_u32 s39, 0
    s_cbranch_scc1 poll3
poll3_done:
l_hkv:
    s_barrier
    s_branch kv_reduce
l_B:
    s_barrier
    s_branch attention
m_entry:
    s_lshr_b32 s23, s22, 1
    s_and_b32 s24, s22, 1
    s_mov_b32 s16, s74
    s_and_b32 s17, s75, 0xffff
    s_mov_b32 s18, 0x400000
    s_mov_b32 s19, 0x20000
    s_lshl_b32 s50, s20, 2
    s_add_u32 s50, s50, s22
    s_lshl_b32 s51, s50, 16
    s_lshl_b32 s39, s21, 7
    s_add_u32 s53, s51, s39
    v_and_b32 v156, 31, v255
    v_lshlrev_b32 v156, 11, v156
    v_lshrrev_b32 v157, 5, v255
    v_lshl_add_u32 v156, v157, 4, v156
    buffer_load_dwordx4 v[112:115], v156, s[16:19], s53 offen offset:0
    buffer_load_dwordx4 v[116:119], v156, s[16:19], s53 offen offset:32
    buffer_load_dwordx4 v[120:123], v156, s[16:19], s53 offen offset:64
    buffer_load_dwordx4 v[124:127], v156, s[16:19], s53 offen offset:96
    s_lshl_b32 s38, s25, 22
    s_mov_b32 s60, s38
    s_add_u32 s61, s60, 0x400000
    s_add_u32 s62, s38, 0x1000000
    s_lshl_b32 s38, s25, 18
    s_add_u32 s64, s38, 0x3500000
    s_add_u32 s65, s64, 0x40000
    s_lshr_b32 s39, s25, 1
    s_lshl_b32 s38, s39, 17
    s_add_u32 s67, s38, 0x3400000
    s_lshl_b32 s38, s39, 21
    s_add_u32 s38, s38, 0x3000000
    s_lshl_b32 s39, s39, 23
    s_add_u32 s39, s39, 0x2000000
    s_bitcmp1_b32 s25, 0
    s_cselect_b32 s63, s39, s38
    s_mul_i32 s38, s25, 0x1800
    s_add_u32 s66, s38, 0x3701800
    s_and_b32 s38, s25, 1
    s_mul_i32 s38, s38, 768
    s_add_u32 s70, s38, 132096
    s_lshl_b32 s39, s23, 13
    v_add_u32 v138, s39, v254
    v_lshrrev_b32 v5, 5, v255
    v_bfe_u32 v6, v255, 2, 2
    v_lshl_add_u32 v5, v5, 2, v6
    v_lshlrev_b32 v5, 7, v5
    v_bfe_u32 v6, v255, 4, 1
    v_bfe_u32 v7, v255, 1, 1
    v_lshl_add_u32 v6, v6, 1, v7
    s_lshl_b32 s39, s24, 2
    v_add_u32 v6, s39, v6
    v_bfe_u32 v7, v255, 3, 1
    v_lshlrev_b32 v7, 2, v7
    v_xor_b32 v6, v6, v7
    v_lshl_add_u32 v5, v6, 4, v5
    v_and_b32 v6, 1, v255
    v_lshl_add_u32 v139, v6, 3, v5
    v_mov_b32 v136, v138
    v_mov_b32 v137, v139
    v_mov_b32 v0, 0
    v_mov_b32 v1, 0
    v_mov_b32 v2, 0
    v_mov_b32 v3, 0
    v_mov_b32 v4, 0
    v_mov_b32 v5, 0
    v_mov_b32 v6, 0
    v_mov_b32 v7, 0
    v_mov_b32 v8, 0
    v_mov_b32 v9, 0
    v_mov_b32 v10, 0
    v_mov_b32 v11, 0
    v_mov_b32 v12, 0
    v_mov_b32 v13, 0
    v_mov_b32 v14, 0
    v_mov_b32 v15, 0
    v_mov_b32 v16, 0
    v_mov_b32 v17, 0
    v_mov_b32 v18, 0
    v_mov_b32 v19, 0
    v_mov_b32 v20, 0
    v_mov_b32 v21, 0
    v_mov_b32 v22, 0
    v_mov_b32 v23, 0
    v_mov_b32 v24, 0
    v_mov_b32 v25, 0
    v_mov_b32 v26, 0
    v_mov_b32 v27, 0
    v_mov_b32 v28, 0
    v_mov_b32 v29, 0
    v_mov_b32 v30, 0
    v_mov_b32 v31, 0
    v_mov_b32 v32, 0
    v_mov_b32 v33, 0
    v_mov_b32 v34, 0
    v_mov_b32 v35, 0
    v_mov_b32 v36, 0
    v_mov_b32 v37, 0
    v_mov_b32 v38, 0
    v_mov_b32 v39, 0
    v_mov_b32 v40, 0
    v_mov_b32 v41, 0
    v_mov_b32 v42, 0
    v_mov_b32 v43, 0
    v_mov_b32 v44, 0
    v_mov_b32 v45, 0
    v_mov_b32 v46, 0
    v_mov_b32 v47, 0
    v_mov_b32 v48, 0
    v_mov_b32 v49, 0
    v_mov_b32 v50, 0
    v_mov_b32 v51, 0
    v_mov_b32 v52, 0
    v_mov_b32 v53, 0
    v_mov_b32 v54, 0
    v_mov_b32 v55, 0
    v_mov_b32 v56, 0
    v_mov_b32 v57, 0
    v_mov_b32 v58, 0
    v_mov_b32 v59, 0
    v_mov_b32 v60, 0
    v_mov_b32 v61, 0
    v_mov_b32 v62, 0
    v_mov_b32 v63, 0
    v_mov_b32 v64, 0
    v_mov_b32 v65, 0
    v_mov_b32 v66, 0
    v_mov_b32 v67, 0
    v_mov_b32 v68, 0
    v_mov_b32 v69, 0
    v_mov_b32 v70, 0
    v_mov_b32 v71, 0
    v_mov_b32 v72, 0
    v_mov_b32 v73, 0
    v_mov_b32 v74, 0
    v_mov_b32 v75, 0
    v_mov_b32 v76, 0
    v_mov_b32 v77, 0
    v_mov_b32 v78, 0
    v_mov_b32 v79, 0
    v_mov_b32 v80, 0
    v_mov_b32 v81, 0
    v_mov_b32 v82, 0
    v_mov_b32 v83, 0
    v_mov_b32 v84, 0
    v_mov_b32 v85, 0
    v_mov_b32 v86, 0
    v_mov_b32 v87, 0
    v_mov_b32 v88, 0
    v_mov_b32 v89, 0
    v_mov_b32 v90, 0
    v_mov_b32 v91, 0
    v_mov_b32 v92, 0
    v_mov_b32 v93, 0
    v_mov_b32 v94, 0
    v_mov_b32 v95, 0
    s_mov_b32 s40, 0
    s_mov_b32 s49, 16
    s_lshl_b32 s39, s21, 12
    s_add_u32 s77, s51, s39
    s_add_u32 s77, s77, s60
    s_lshl_b32 s39, s21, 14
    s_lshl_b32 s78, s50, 8
    s_add_u32 s78, s78, s39
    s_add_u32 s78, s78, s64
    s_barrier
m_layer:
    s_cmp_lt_u32 s25, 2
    s_cbranch_scc0 m_nocs
    v_lshrrev_b32 v140, 5, v255
    v_bfe_u32 v141, v255, 2, 2
    v_lshl_add_u32 v140, v140, 2, v141
    v_lshlrev_b32 v140, 7, v140
    v_bfe_u32 v141, v255, 4, 1
    v_bfe_u32 v142, v255, 1, 1
    v_lshl_add_u32 v141, v141, 1, v142
    v_bfe_u32 v142, v255, 3, 1
    v_lshlrev_b32 v142, 2, v142
    v_xor_b32 v141, v141, v142
    v_lshl_add_u32 v140, v141, 4, v140
    v_and_b32 v141, 1, v255
    v_lshl_add_u32 v140, v141, 3, v140
    s_lshl_b32 s39, s22, 11
    v_add_u32 v140, s39, v140
    v_xor_b32 v141, 64, v140
    v_add_u32 v142, 138240, v140
    ds_read_b64_tr_b16 v[160:161], v142 offset:0
    ds_read_b64_tr_b16 v[162:163], v142 offset:1024
    v_add_u32 v142, 138240, v141
    ds_read_b64_tr_b16 v[164:165], v142 offset:0
    ds_read_b64_tr_b16 v[166:167], v142 offset:1024
    v_add_u32 v142, 146432, v140
    ds_read_b64_tr_b16 v[168:169], v142 offset:0
    ds_read_b64_tr_b16 v[170:171], v142 offset:1024
    v_add_u32 v142, 146432, v141
    ds_read_b64_tr_b16 v[172:173], v142 offset:0
    ds_read_b64_tr_b16 v[174:175], v142 offset:1024
    v_add_u32 v142, 155648, v140
    ds_read_b64_tr_b16 v[176:177], v142 offset:0
    ds_read_b64_tr_b16 v[178:179], v142 offset:1024
    v_add_u32 v142, 155648, v141
    ds_read_b64_tr_b16 v[180:181], v142 offset:0
    ds_read_b64_tr_b16 v[182:183], v142 offset:1024
    v_mov_b32 v143, 0x3f803f80
    v_mov_b32 v150, 0
    v_mov_b32 v151, 0
    v_mov_b32 v152, 0
    v_mov_b32 v153, 0
    v_mov_b32 v154, 0
    v_mov_b32 v155, 0
    s_waitcnt lgkmcnt(0)
    v_dot2c_f32_bf16 v150, v160, v143
    v_dot2c_f32_bf16 v151, v164, v143
    v_dot2c_f32_bf16 v152, v168, v143
    v_dot2c_f32_bf16 v153, v172, v143
    v_dot2c_f32_bf16 v154, v176, v143
    v_dot2c_f32_bf16 v155, v180, v143
    v_dot2c_f32_bf16 v150, v161, v143
    v_dot2c_f32_bf16 v151, v165, v143
    v_dot2c_f32_bf16 v152, v169, v143
    v_dot2c_f32_bf16 v153, v173, v143
    v_dot2c_f32_bf16 v154, v177, v143
    v_dot2c_f32_bf16 v155, v181, v143
    v_dot2c_f32_bf16 v150, v162, v143
    v_dot2c_f32_bf16 v151, v166, v143
    v_dot2c_f32_bf16 v152, v170, v143
    v_dot2c_f32_bf16 v153, v174, v143
    v_dot2c_f32_bf16 v154, v178, v143
    v_dot2c_f32_bf16 v155, v182, v143
    v_dot2c_f32_bf16 v150, v163, v143
    v_dot2c_f32_bf16 v151, v167, v143
    v_dot2c_f32_bf16 v152, v171, v143
    v_dot2c_f32_bf16 v153, v175, v143
    v_dot2c_f32_bf16 v154, v179, v143
    v_dot2c_f32_bf16 v155, v183, v143
    s_nop 2
    v_mov_b32 v184, v150
    v_mov_b32 v185, v151
    v_mov_b32 v186, v152
    v_mov_b32 v187, v153
    v_mov_b32 v188, v154
    v_mov_b32 v189, v155
    s_nop 1
    v_permlane32_swap_b32 v150, v184
    v_permlane32_swap_b32 v151, v185
    v_permlane32_swap_b32 v152, v186
    v_permlane32_swap_b32 v153, v187
    v_permlane32_swap_b32 v154, v188
    v_permlane32_swap_b32 v155, v189
    s_nop 1
    v_add_f32 v150, v150, v184
    v_add_f32 v151, v151, v185
    v_add_f32 v152, v152, v186
    v_add_f32 v153, v153, v187
    v_add_f32 v154, v154, v188
    v_add_f32 v155, v155, v189
    v_and_b32 v142, 31, v255
    v_lshlrev_b32 v142, 2, v142
    s_lshl_b32 s39, s22, 11
    s_add_u32 s39, s39, 138240
    v_add_u32 v142, s39, v142
    ds_write_b32 v142, v150 offset:0
    ds_write_b32 v142, v151 offset:128
    ds_write_b32 v142, v152 offset:256
    ds_write_b32 v142, v153 offset:384
    ds_write_b32 v142, v154 offset:512
    ds_write_b32 v142, v155 offset:640
    s_waitcnt lgkmcnt(0)
m_nocs:
    s_cmp_eq_u32 s25, 0
    s_cbranch_scc0 m_std
    v_and_b32 v5, 31, v255
    v_lshlrev_b32 v6, 7, v5
    s_lshl_b32 s39, s23, 13
    v_add_u32 v6, s39, v6
    v_bfe_u32 v5, v5, 1, 3
    v_lshrrev_b32 v7, 5, v255
    v_add_u32 v8, 0, v7
    v_xor_b32 v8, v8, v5
    v_lshl_add_u32 v144, v8, 4, v6
    v_mov_b32 v140, v144
    v_add_u32 v8, 2, v7
    v_xor_b32 v8, v8, v5
    v_lshl_add_u32 v145, v8, 4, v6
    v_mov_b32 v141, v145
    v_add_u32 v8, 4, v7
    v_xor_b32 v8, v8, v5
    v_lshl_add_u32 v146, v8, 4, v6
    v_mov_b32 v142, v146
    v_add_u32 v8, 6, v7
    v_xor_b32 v8, v8, v5
    v_lshl_add_u32 v147, v8, 4, v6
    v_mov_b32 v143, v147
    v_lshrrev_b32 v5, 5, v255
    v_lshlrev_b32 v5, 9, v5
    v_add_u32 v139, v139, v5
    v_mov_b32 v137, v139
    v_mov_b32 v5, 0
    v_mov_b32 v6, 0
    v_mov_b32 v7, 0
    v_mov_b32 v8, 0
    v_mov_b32 v150, 0x3f803f80
    s_waitcnt vmcnt(0)
    v_readfirstlane_b32 s69, v218
    v_permlane32_swap_b32 v112, v114
    v_permlane32_swap_b32 v113, v115
    v_permlane32_swap_b32 v116, v118
    v_permlane32_swap_b32 v117, v119
    v_permlane32_swap_b32 v120, v122
    v_permlane32_swap_b32 v121, v123
    v_permlane32_swap_b32 v124, v126
    v_permlane32_swap_b32 v125, v127
    s_add_u32 s69, s69, 1
    buffer_store_dwordx4 v[112:115], v254, s[8:11], s77 offen offset:0 sc1
    buffer_store_dwordx4 v[116:119], v254, s[8:11], s77 offen offset:1024 sc1
    buffer_store_dwordx4 v[120:123], v254, s[8:11], s77 offen offset:2048 sc1
    buffer_store_dwordx4 v[124:127], v254, s[8:11], s77 offen offset:3072 sc1
    v_mov_b32 v152, 0
    v_mov_b32 v153, 0
    v_dot2c_f32_bf16 v152, v112, v150
    v_dot2c_f32_bf16 v153, v112, v112
    v_dot2c_f32_bf16 v152, v113, v150
    v_dot2c_f32_bf16 v153, v113, v113
    v_dot2c_f32_bf16 v152, v114, v150
    v_dot2c_f32_bf16 v153, v114, v114
    v_dot2c_f32_bf16 v152, v115, v150
    v_dot2c_f32_bf16 v153, v115, v115
    v_dot2c_f32_bf16 v152, v116, v150
    v_dot2c_f32_bf16 v153, v116, v116
    v_dot2c_f32_bf16 v152, v117, v150
    v_dot2c_f32_bf16 v153, v117, v117
    v_dot2c_f32_bf16 v152, v118, v150
    v_dot2c_f32_bf16 v153, v118, v118
    v_dot2c_f32_bf16 v152, v119, v150
    v_dot2c_f32_bf16 v153, v119, v119
    v_dot2c_f32_bf16 v152, v120, v150
    v_dot2c_f32_bf16 v153, v120, v120
    v_dot2c_f32_bf16 v152, v121, v150
    v_dot2c_f32_bf16 v153, v121, v121
    v_dot2c_f32_bf16 v152, v122, v150
    v_dot2c_f32_bf16 v153, v122, v122
    v_dot2c_f32_bf16 v152, v123, v150
    v_dot2c_f32_bf16 v153, v123, v123
    v_dot2c_f32_bf16 v152, v124, v150
    v_dot2c_f32_bf16 v153, v124, v124
    v_dot2c_f32_bf16 v152, v125, v150
    v_dot2c_f32_bf16 v153, v125, v125
    v_dot2c_f32_bf16 v152, v126, v150
    v_dot2c_f32_bf16 v153, v126, v126
    v_dot2c_f32_bf16 v152, v127, v150
    v_dot2c_f32_bf16 v153, v127, v127
    s_nop 2
    v_mov_b32 v154, v152
    v_mov_b32 v155, v153
    s_nop 1
    v_permlane32_swap_b32 v152, v154
    v_permlane32_swap_b32 v153, v155
    s_nop 1
    v_add_f32 v152, v152, v154
    v_add_f32 v153, v153, v155
    v_and_b32 v156, 31, v255
    v_lshlrev_b32 v156, 3, v156
    s_mov_b64 exec, 0xffffffff
    buffer_store_dwordx2 v[152:153], v156, s[8:11], s78 offen sc1
    s_mov_b64 exec, -1
    s_barrier
    ds_read_b128 v[96:99], v140
    ds_read_b64_tr_b16 v[104:105], v137 offset:16384
    ds_read_b64_tr_b16 v[106:107], v137 offset:16896
    ds_read_b128 v[100:103], v140 offset:4096
    ds_read_b64_tr_b16 v[108:109], v137 offset:24576
    ds_read_b64_tr_b16 v[110:111], v137 offset:25088
    ds_read_b64_tr_b16 v[112:113], v137 offset:32768
    ds_read_b64_tr_b16 v[114:115], v137 offset:33280
    s_waitcnt lgkmcnt(5)
    v_mfma_f32_32x32x16_bf16 v[0:15], v[104:107], v[96:99], v[0:15]
    ds_read_b128 v[116:119], v141
    ds_read_b64_tr_b16 v[124:125], v137 offset:18432
    s_waitcnt lgkmcnt(6)
    v_mfma_f32_32x32x16_bf16 v[16:31], v[104:107], v[100:103], v[16:31]
    ds_read_b64_tr_b16 v[126:127], v137 offset:18944
    ds_read_b128 v[120:123], v141 offset:4096
    s_waitcnt lgkmcnt(6)
    v_mfma_f32_32x32x16_bf16 v[32:47], v[108:111], v[96:99], v[32:47]
    ds_read_b64_tr_b16 v[128:129], v137 offset:26624
    ds_read_b64_tr_b16 v[130:131], v137 offset:27136
    v_mfma_f32_32x32x16_bf16 v[48:63], v[108:111], v[100:103], v[48:63]
    ds_read_b64_tr_b16 v[132:133], v137 offset:34816
    ds_read_b64_tr_b16 v[134:135], v137 offset:35328
    s_waitcnt lgkmcnt(8)
    v_mfma_f32_32x32x16_bf16 v[64:79], v[96:99], v[112:115], v[64:79]
    v_mfma_f32_32x32x16_bf16 v[80:95], v[100:103], v[112:115], v[80:95]
    s_waitcnt lgkmcnt(5)
    v_mfma_f32_32x32x16_bf16 v[0:15], v[124:127], v[116:119], v[0:15]
    ds_read_b128 v[96:99], v142
    ds_read_b64_tr_b16 v[104:105], v137 offset:20480
    s_waitcnt lgkmcnt(6)
    v_mfma_f32_32x32x16_bf16 v[16:31], v[124:127], v[120:123], v[16:31]
    ds_read_b64_tr_b16 v[106:107], v137 offset:20992
    ds_read_b128 v[100:103], v142 offset:4096
    s_waitcnt lgkmcnt(6)
    v_mfma_f32_32x32x16_bf16 v[32:47], v[128:131], v[116:119], v[32:47]
    ds_read_b64_tr_b16 v[108:109], v137 offset:28672
    ds_read_b64_tr_b16 v[110:111], v137 offset:29184
    v_mfma_f32_32x32x16_bf16 v[48:63], v[128:131], v[120:123], v[48:63]
    ds_read_b64_tr_b16 v[112:113], v137 offset:36864
    ds_read_b64_tr_b16 v[114:115], v137 offset:37376
    s_waitcnt lgkmcnt(8)
    v_mfma_f32_32x32x16_bf16 v[64:79], v[116:119], v[132:135], v[64:79]
    v_mfma_f32_32x32x16_bf16 v[80:95], v[120:123], v[132:135], v[80:95]
    s_waitcnt lgkmcnt(5)
    v_mfma_f32_32x32x16_bf16 v[0:15], v[104:107], v[96:99], v[0:15]
    ds_read_b128 v[116:119], v143
    ds_read_b64_tr_b16 v[124:125], v137 offset:22528
    s_waitcnt lgkmcnt(6)
    v_mfma_f32_32x32x16_bf16 v[16:31], v[104:107], v[100:103], v[16:31]
    ds_read_b64_tr_b16 v[126:127], v137 offset:23040
    ds_read_b128 v[120:123], v143 offset:4096
    s_waitcnt lgkmcnt(6)
    v_mfma_f32_32x32x16_bf16 v[32:47], v[108:111], v[96:99], v[32:47]
    ds_read_b64_tr_b16 v[128:129], v137 offset:30720
    ds_read_b64_tr_b16 v[130:131], v137 offset:31232
    v_mfma_f32_32x32x16_bf16 v[48:63], v[108:111], v[100:103], v[48:63]
    ds_read_b64_tr_b16 v[132:133], v137 offset:38912
    ds_read_b64_tr_b16 v[134:135], v137 offset:39424
    s_waitcnt lgkmcnt(8)
    v_mfma_f32_32x32x16_bf16 v[64:79], v[96:99], v[112:115], v[64:79]
    v_mfma_f32_32x32x16_bf16 v[80:95], v[100:103], v[112:115], v[80:95]
    s_waitcnt vmcnt(0)
    s_waitcnt lgkmcnt(0)
    s_add_u32 s40, s40, 40960
    s_cmp_eq_u32 s40, 122880
    s_cselect_b32 s40, 0, s40
    v_add_u32 v140, s40, v144
    v_add_u32 v141, s40, v145
    v_add_u32 v142, s40, v146
    v_add_u32 v143, s40, v147
    v_add_u32 v137, s40, v139
    v_mfma_f32_32x32x16_bf16 v[0:15], v[124:127], v[116:119], v[0:15]
    s_barrier
    ds_read_b128 v[96:99], v140
    ds_read_b64_tr_b16 v[104:105], v137 offset:16384
    v_mfma_f32_32x32x16_bf16 v[16:31], v[124:127], v[120:123], v[16:31]
    ds_read_b64_tr_b16 v[106:107], v137 offset:16896
    ds_read_b128 v[100:103], v140 offset:4096
    v_mfma_f32_32x32x16_bf16 v[32:47], v[128:131], v[116:119], v[32:47]
    ds_read_b64_tr_b16 v[108:109], v137 offset:24576
    ds_read_b64_tr_b16 v[110:111], v137 offset:25088
    v_mfma_f32_32x32x16_bf16 v[48:63], v[128:131], v[120:123], v[48:63]
    ds_read_b64_tr_b16 v[112:113], v137 offset:32768
    ds_read_b64_tr_b16 v[114:115], v137 offset:33280
    v_mfma_f32_32x32x16_bf16 v[64:79], v[116:119], v[132:135], v[64:79]
    v_mfma_f32_32x32x16_bf16 v[80:95], v[120:123], v[132:135], v[80:95]
    s_cmp_eq_u32 s22, 0
    s_cbranch_scc0 m_sx0
    s_lshl_b32 s38, s20, 7
    s_add_u32 s38, s38, s66
    s_sub_u32 s38, s38, 2048
    s_lshl_b32 s39, s21, 3
    v_mov_b32 v250, s39
    v_mov_b32 v248, s69
    v_not_b32 v249, v248
    s_mov_b64 exec, 1
    buffer_store_dwordx2 v[248:249], v250, s[8:11], s38 offen sc1
    s_mov_b64 exec, -1
m_sx0:
    s_sub_u32 s49, s49, 1
m_loopn:
    s_cmp_eq_u32 s49, 11
    s_cbranch_scc0 m_pfa
    s_mov_b32 s16, s30
    s_and_b32 s17, s31, 0xffff
    s_mov_b32 s18, 0x200000
    s_mov_b32 s19, 0x20000
    s_lshl_b32 s43, s20, 6
    s_lshl_b32 s44, s22, 4
    s_add_u32 s43, s43, s44
    s_lshl_b32 s43, s43, 11
    s_lshl_b32 s44, s21, 7
    s_add_u32 s43, s43, s44
    v_lshrrev_b32 v222, 3, v255
    v_lshlrev_b32 v222, 11, v222
    v_and_b32 v223, 7, v255
    v_lshl_add_u32 v222, v223, 4, v222
    buffer_load_dwordx4 v[240:243], v222, s[16:19], s43 offen
    s_add_u32 s43, s43, 16384
    buffer_load_dwordx4 v[244:247], v222, s[16:19], s43 offen
m_pfa:
    s_cmp_eq_u32 s49, 4
    s_cbranch_scc0 m_pfo
    s_mov_b32 s16, s32
    s_and_b32 s17, s33, 0xffff
    s_mov_b32 s18, 0x200000
    s_mov_b32 s19, 0x20000
    s_lshl_b32 s43, s20, 6
    s_lshl_b32 s44, s22, 4
    s_add_u32 s43, s43, s44
    s_lshl_b32 s43, s43, 11
    s_lshl_b32 s44, s21, 7
    s_add_u32 s43, s43, s44
    v_lshrrev_b32 v222, 3, v255
    v_lshlrev_b32 v222, 11, v222
    v_and_b32 v223, 7, v255
    v_lshl_add_u32 v222, v223, 4, v222
    buffer_load_dwordx4 v[240:243], v222, s[16:19], s43 offen
    s_add_u32 s43, s43, 16384
    buffer_load_dwordx4 v[244:247], v222, s[16:19], s43 offen
m_pfo:
    s_waitcnt lgkmcnt(5)
    v_mfma_f32_32x32x16_bf16 v[0:15], v[104:107], v[96:99], v[0:15]
    ds_read_b128 v[116:119], v141
    ds_read_b64_tr_b16 v[124:125], v137 offset:18432
    s_waitcnt lgkmcnt(6)
    v_mfma_f32_32x32x16_bf16 v[16:31], v[104:107], v[100:103], v[16:31]
    ds_read_b64_tr_b16 v[126:127], v137 offset:18944
    ds_read_b128 v[120:123], v141 offset:4096
    s_waitcnt lgkmcnt(6)
    v_mfma_f32_32x32x16_bf16 v[32:47], v[108:111], v[96:99], v[32:47]
    ds_read_b64_tr_b16 v[128:129], v137 offset:26624
    ds_read_b64_tr_b16 v[130:131], v137 offset:27136
    v_mfma_f32_32x32x16_bf16 v[48:63], v[108:111], v[100:103], v[48:63]
    ds_read_b64_tr_b16 v[132:133], v137 offset:34816
    ds_read_b64_tr_b16 v[134:135], v137 offset:35328
    s_waitcnt lgkmcnt(8)
    v_mfma_f32_32x32x16_bf16 v[64:79], v[96:99], v[112:115], v[64:79]
    v_mfma_f32_32x32x16_bf16 v[80:95], v[100:103], v[112:115], v[80:95]
    s_waitcnt lgkmcnt(5)
    v_mfma_f32_32x32x16_bf16 v[0:15], v[124:127], v[116:119], v[0:15]
    ds_read_b128 v[96:99], v142
    ds_read_b64_tr_b16 v[104:105], v137 offset:20480
    s_waitcnt lgkmcnt(6)
    v_mfma_f32_32x32x16_bf16 v[16:31], v[124:127], v[120:123], v[16:31]
    ds_read_b64_tr_b16 v[106:107], v137 offset:20992
    ds_read_b128 v[100:103], v142 offset:4096
    s_waitcnt lgkmcnt(6)
    v_mfma_f32_32x32x16_bf16 v[32:47], v[128:131], v[116:119], v[32:47]
    ds_read_b64_tr_b16 v[108:109], v137 offset:28672
    ds_read_b64_tr_b16 v[110:111], v137 offset:29184
    v_mfma_f32_32x32x16_bf16 v[48:63], v[128:131], v[120:123], v[48:63]
    ds_read_b64_tr_b16 v[112:113], v137 offset:36864
    ds_read_b64_tr_b16 v[114:115], v137 offset:37376
    s_waitcnt lgkmcnt(8)
    v_mfma_f32_32x32x16_bf16 v[64:79], v[116:119], v[132:135], v[64:79]
    v_mfma_f32_32x32x16_bf16 v[80:95], v[120:123], v[132:135], v[80:95]
    s_waitcnt lgkmcnt(5)
    v_mfma_f32_32x32x16_bf16 v[0:15], v[104:107], v[96:99], v[0:15]
    ds_read_b128 v[116:119], v143
    ds_read_b64_tr_b16 v[124:125], v137 offset:22528
    s_waitcnt lgkmcnt(6)
    v_mfma_f32_32x32x16_bf16 v[16:31], v[104:107], v[100:103], v[16:31]
    ds_read_b64_tr_b16 v[126:127], v137 offset:23040
    ds_read_b128 v[120:123], v143 offset:4096
    s_waitcnt lgkmcnt(6)
    v_mfma_f32_32x32x16_bf16 v[32:47], v[108:111], v[96:99], v[32:47]
    ds_read_b64_tr_b16 v[128:129], v137 offset:30720
    ds_read_b64_tr_b16 v[130:131], v137 offset:31232
    v_mfma_f32_32x32x16_bf16 v[48:63], v[108:111], v[100:103], v[48:63]
    ds_read_b64_tr_b16 v[132:133], v137 offset:38912
    ds_read_b64_tr_b16 v[134:135], v137 offset:39424
    s_waitcnt lgkmcnt(8)
    v_mfma_f32_32x32x16_bf16 v[64:79], v[96:99], v[112:115], v[64:79]
    v_mfma_f32_32x32x16_bf16 v[80:95], v[100:103], v[112:115], v[80:95]
    s_waitcnt lgkmcnt(0)
    s_add_u32 s40, s40, 40960
    s_cmp_eq_u32 s40, 122880
    s_cselect_b32 s40, 0, s40
    v_add_u32 v140, s40, v144
    v_add_u32 v141, s40, v145
    v_add_u32 v142, s40, v146
    v_add_u32 v143, s40, v147
    v_add_u32 v137, s40, v139
    v_mfma_f32_32x32x16_bf16 v[0:15], v[124:127], v[116:119], v[0:15]
    s_barrier
    ds_read_b128 v[96:99], v140
    ds_read_b64_tr_b16 v[104:105], v137 offset:16384
    v_mfma_f32_32x32x16_bf16 v[16:31], v[124:127], v[120:123], v[16:31]
    ds_read_b64_tr_b16 v[106:107], v137 offset:16896
    ds_read_b128 v[100:103], v140 offset:4096
    v_mfma_f32_32x32x16_bf16 v[32:47], v[128:131], v[116:119], v[32:47]
    ds_read_b64_tr_b16 v[108:109], v137 offset:24576
    ds_read_b64_tr_b16 v[110:111], v137 offset:25088
    v_mfma_f32_32x32x16_bf16 v[48:63], v[128:131], v[120:123], v[48:63]
    ds_read_b64_tr_b16 v[112:113], v137 offset:32768
    ds_read_b64_tr_b16 v[114:115], v137 offset:33280
    v_mfma_f32_32x32x16_bf16 v[64:79], v[116:119], v[132:135], v[64:79]
    v_mfma_f32_32x32x16_bf16 v[80:95], v[120:123], v[132:135], v[80:95]
    s_sub_u32 s49, s49, 1
    s_cmp_lg_u32 s49, 0
    s_cbranch_scc1 m_loopn
    s_branch m_done
m_std:
    s_barrier
    ds_read_b128 v[96:99], v136 offset:0
    ds_read_b64_tr_b16 v[104:105], v137 offset:16384
    ds_read_b64_tr_b16 v[106:107], v137 offset:17408
    ds_read_b128 v[100:103], v136 offset:4096
    ds_read_b64_tr_b16 v[108:109], v137 offset:24576
    ds_read_b64_tr_b16 v[110:111], v137 offset:25600
    ds_read_b64_tr_b16 v[112:113], v137 offset:32768
    ds_read_b64_tr_b16 v[114:115], v137 offset:33792
m_loop:
    s_waitcnt lgkmcnt(5)
    v_mfma_f32_32x32x16_bf16 v[0:15], v[104:107], v[96:99], v[0:15]
    ds_read_b128 v[116:119], v136 offset:1024
    ds_read_b64_tr_b16 v[124:125], v137 offset:18432
    s_waitcnt lgkmcnt(6)
    v_mfma_f32_32x32x16_bf16 v[16:31], v[104:107], v[100:103], v[16:31]
    ds_read_b64_tr_b16 v[126:127], v137 offset:19456
    ds_read_b128 v[120:123], v136 offset:5120
    s_waitcnt lgkmcnt(6)
    v_mfma_f32_32x32x16_bf16 v[32:47], v[108:111], v[96:99], v[32:47]
    ds_read_b64_tr_b16 v[128:129], v137 offset:26624
    ds_read_b64_tr_b16 v[130:131], v137 offset:27648
    v_mfma_f32_32x32x16_bf16 v[48:63], v[108:111], v[100:103], v[48:63]
    ds_read_b64_tr_b16 v[132:133], v137 offset:34816
    ds_read_b64_tr_b16 v[134:135], v137 offset:35840
    s_waitcnt lgkmcnt(8)
    v_mfma_f32_32x32x16_bf16 v[64:79], v[96:99], v[112:115], v[64:79]
    v_mfma_f32_32x32x16_bf16 v[80:95], v[100:103], v[112:115], v[80:95]
    s_waitcnt lgkmcnt(5)
    v_mfma_f32_32x32x16_bf16 v[0:15], v[124:127], v[116:119], v[0:15]
    ds_read_b128 v[96:99], v136 offset:2048
    ds_read_b64_tr_b16 v[104:105], v137 offset:20480
    s_waitcnt lgkmcnt(6)
    v_mfma_f32_32x32x16_bf16 v[16:31], v[124:127], v[120:123], v[16:31]
    ds_read_b64_tr_b16 v[106:107], v137 offset:21504
    ds_read_b128 v[100:103], v136 offset:6144
    s_waitcnt lgkmcnt(6)
    v_mfma_f32_32x32x16_bf16 v[32:47], v[128:131], v[116:119], v[32:47]
    ds_read_b64_tr_b16 v[108:109], v137 offset:28672
    ds_read_b64_tr_b16 v[110:111], v137 offset:29696
    v_mfma_f32_32x32x16_bf16 v[48:63], v[128:131], v[120:123], v[48:63]
    ds_read_b64_tr_b16 v[112:113], v137 offset:36864
    ds_read_b64_tr_b16 v[114:115], v137 offset:37888
    s_waitcnt lgkmcnt(8)
    v_mfma_f32_32x32x16_bf16 v[64:79], v[116:119], v[132:135], v[64:79]
    v_mfma_f32_32x32x16_bf16 v[80:95], v[120:123], v[132:135], v[80:95]
    s_waitcnt lgkmcnt(5)
    v_mfma_f32_32x32x16_bf16 v[0:15], v[104:107], v[96:99], v[0:15]
    ds_read_b128 v[116:119], v136 offset:3072
    ds_read_b64_tr_b16 v[124:125], v137 offset:22528
    s_waitcnt lgkmcnt(6)
    v_mfma_f32_32x32x16_bf16 v[16:31], v[104:107], v[100:103], v[16:31]
    ds_read_b64_tr_b16 v[126:127], v137 offset:23552
    ds_read_b128 v[120:123], v136 offset:7168
    s_waitcnt lgkmcnt(6)
    v_mfma_f32_32x32x16_bf16 v[32:47], v[108:111], v[96:99], v[32:47]
    ds_read_b64_tr_b16 v[128:129], v137 offset:30720
    ds_read_b64_tr_b16 v[130:131], v137 offset:31744
    v_mfma_f32_32x32x16_bf16 v[48:63], v[108:111], v[100:103], v[48:63]
    ds_read_b64_tr_b16 v[132:133], v137 offset:38912
    ds_read_b64_tr_b16 v[134:135], v137 offset:39936
    s_waitcnt lgkmcnt(8)
    v_mfma_f32_32x32x16_bf16 v[64:79], v[96:99], v[112:115], v[64:79]
    v_mfma_f32_32x32x16_bf16 v[80:95], v[100:103], v[112:115], v[80:95]
    s_waitcnt lgkmcnt(0)
    s_add_u32 s40, s40, 40960
    s_cmp_eq_u32 s40, 122880
    s_cselect_b32 s40, 0, s40
    v_add_u32 v136, s40, v138
    v_add_u32 v137, s40, v139
    v_mfma_f32_32x32x16_bf16 v[0:15], v[124:127], v[116:119], v[0:15]
    s_barrier
    ds_read_b128 v[96:99], v136 offset:0
    ds_read_b64_tr_b16 v[104:105], v137 offset:16384
    v_mfma_f32_32x32x16_bf16 v[16:31], v[124:127], v[120:123], v[16:31]
    ds_read_b64_tr_b16 v[106:107], v137 offset:17408
    ds_read_b128 v[100:103], v136 offset:4096
    v_mfma_f32_32x32x16_bf16 v[32:47], v[128:131], v[116:119], v[32:47]
    ds_read_b64_tr_b16 v[108:109], v137 offset:24576
    ds_read_b64_tr_b16 v[110:111], v137 offset:25600
    v_mfma_f32_32x32x16_bf16 v[48:63], v[128:131], v[120:123], v[48:63]
    ds_read_b64_tr_b16 v[112:113], v137 offset:32768
    ds_read_b64_tr_b16 v[114:115], v137 offset:33792
    v_mfma_f32_32x32x16_bf16 v[64:79], v[116:119], v[132:135], v[64:79]
    v_mfma_f32_32x32x16_bf16 v[80:95], v[120:123], v[132:135], v[80:95]
    s_sub_u32 s49, s49, 1
    s_cmp_lg_u32 s49, 0
    s_cbranch_scc1 m_loop
m_done:
    s_waitcnt vmcnt(0) lgkmcnt(0)
    s_bitcmp1_b32 s25, 0
    s_cbranch_scc1 m_B
    v_and_b32 v148, 31, v255
    s_lshl_b32 s39, s23, 8
    v_lshlrev_b32 v148, 2, v148
    v_add_u32 v148, s39, v148
    v_add_u32 v148, 131072, v148
    ds_read_b32 v150, v148 offset:0
    ds_read_b32 v154, v148 offset:512
    ds_read_b32 v152, v148 offset:128
    ds_read_b32 v156, v148 offset:640
    v_lshrrev_b32 v149, 5, v255
    v_lshlrev_b32 v149, 4, v149
    s_lshl_b32 s39, s24, 7
    s_add_u32 s39, s39, s70
    v_add_u32 v149, s39, v149
    ds_read_b128 v[180:183], v149 offset:256
    ds_read_b128 v[184:187], v149 offset:288
    ds_read_b128 v[188:191], v149 offset:320
    ds_read_b128 v[192:195], v149 offset:352
    v_and_b32 v145, 31, v255
    v_lshlrev_b32 v145, 2, v145
    s_lshl_b32 s39, s24, 7
    s_add_u32 s39, s39, s70
    v_add_u32 v145, s39, v145
    ds_read_b32 v162, v145 offset:512
    v_lshrrev_b32 v144, 5, v255
    v_lshlrev_b32 v144, 4, v144
    s_lshl_b32 s39, s23, 8
    v_add_u32 v144, s39, v144
    v_add_u32 v144, 131072, v144
    ds_read_b128 v[196:199], v144 offset:0
    ds_read_b128 v[212:215], v144 offset:512
    ds_read_b128 v[200:203], v144 offset:32
    ds_read_b128 v[216:219], v144 offset:544
    ds_read_b128 v[204:207], v144 offset:64
    ds_read_b128 v[220:223], v144 offset:576
    ds_read_b128 v[208:211], v144 offset:96
    ds_read_b128 v[224:227], v144 offset:608
    s_lshl_b32 s50, s21, 1
    s_add_u32 s50, s50, s24
    s_lshl_b32 s51, s20, 2
    s_lshl_b32 s39, s23, 1
    s_add_u32 s51, s51, s39
    s_waitcnt lgkmcnt(0)
    v_pk_fma_f32 v[64:65], v[196:197], v[162:163], v[64:65] op_sel_hi:[1,0,1]
    v_pk_fma_f32 v[66:67], v[198:199], v[162:163], v[66:67] op_sel_hi:[1,0,1]
    v_pk_fma_f32 v[68:69], v[200:201], v[162:163], v[68:69] op_sel_hi:[1,0,1]
    v_pk_fma_f32 v[70:71], v[202:203], v[162:163], v[70:71] op_sel_hi:[1,0,1]
    v_pk_fma_f32 v[72:73], v[204:205], v[162:163], v[72:73] op_sel_hi:[1,0,1]
    v_pk_fma_f32 v[74:75], v[206:207], v[162:163], v[74:75] op_sel_hi:[1,0,1]
    v_pk_fma_f32 v[76:77], v[208:209], v[162:163], v[76:77] op_sel_hi:[1,0,1]
    v_pk_fma_f32 v[78:79], v[210:211], v[162:163], v[78:79] op_sel_hi:[1,0,1]
    v_pk_mul_f32 v[64:65], v[64:65], v[212:213]
    v_pk_mul_f32 v[66:67], v[66:67], v[214:215]
    v_pk_mul_f32 v[68:69], v[68:69], v[216:217]
    v_pk_mul_f32 v[70:71], v[70:71], v[218:219]
    v_pk_mul_f32 v[72:73], v[72:73], v[220:221]
    v_pk_mul_f32 v[74:75], v[74:75], v[222:223]
    v_pk_mul_f32 v[76:77], v[76:77], v[224:225]
    v_pk_mul_f32 v[78:79], v[78:79], v[226:227]
    v_lshrrev_b32 v144, 5, v255
    v_lshlrev_b32 v144, 4, v144
    s_lshl_b32 s39, s23, 8
    v_add_u32 v144, s39, v144
    v_add_u32 v144, 131072, v144
    ds_read_b128 v[196:199], v144 offset:128
    ds_read_b128 v[212:215], v144 offset:640
    ds_read_b128 v[200:203], v144 offset:160
    ds_read_b128 v[216:219], v144 offset:672
    ds_read_b128 v[204:207], v144 offset:192
    ds_read_b128 v[220:223], v144 offset:704
    ds_read_b128 v[208:211], v144 offset:224
    ds_read_b128 v[224:227], v144 offset:736
    v_cvt_pk_bf16_f32 v228, v64, v65
    v_cvt_pk_bf16_f32 v229, v66, v67
    v_cvt_pk_bf16_f32 v230, v68, v69
    v_cvt_pk_bf16_f32 v231, v70, v71
    v_cvt_pk_bf16_f32 v232, v72, v73
    v_cvt_pk_bf16_f32 v233, v74, v75
    v_cvt_pk_bf16_f32 v234, v76, v77
    v_cvt_pk_bf16_f32 v235, v78, v79
    v_pk_fma_f32 v[32:33], v[180:181], v[150:151], v[32:33] op_sel_hi:[1,0,1]
    v_pk_fma_f32 v[34:35], v[182:183], v[150:151], v[34:35] op_sel_hi:[1,0,1]
    v_pk_fma_f32 v[36:37], v[184:185], v[150:151], v[36:37] op_sel_hi:[1,0,1]
    v_pk_fma_f32 v[38:39], v[186:187], v[150:151], v[38:39] op_sel_hi:[1,0,1]
    v_pk_fma_f32 v[40:41], v[188:189], v[150:151], v[40:41] op_sel_hi:[1,0,1]
    v_pk_fma_f32 v[42:43], v[190:191], v[150:151], v[42:43] op_sel_hi:[1,0,1]
    v_pk_fma_f32 v[44:45], v[192:193], v[150:151], v[44:45] op_sel_hi:[1,0,1]
    v_pk_fma_f32 v[46:47], v[194:195], v[150:151], v[46:47] op_sel_hi:[1,0,1]
    v_pk_mul_f32 v[32:33], v[32:33], v[154:155] op_sel_hi:[1,0]
    v_pk_mul_f32 v[34:35], v[34:35], v[154:155] op_sel_hi:[1,0]
    v_pk_mul_f32 v[36:37], v[36:37], v[154:155] op_sel_hi:[1,0]
    v_pk_mul_f32 v[38:39], v[38:39], v[154:155] op_sel_hi:[1,0]
    v_pk_mul_f32 v[40:41], v[40:41], v[154:155] op_sel_hi:[1,0]
    v_pk_mul_f32 v[42:43], v[42:43], v[154:155] op_sel_hi:[1,0]
    v_pk_mul_f32 v[44:45], v[44:45], v[154:155] op_sel_hi:[1,0]
    v_pk_mul_f32 v[46:47], v[46:47], v[154:155] op_sel_hi:[1,0]
    v_pk_fma_f32 v[48:49], v[180:181], v[152:153], v[48:49] op_sel_hi:[1,0,1]
    v_pk_fma_f32 v[50:51], v[182:183], v[152:153], v[50:51] op_sel_hi:[1,0,1]
    v_pk_fma_f32 v[52:53], v[184:185], v[152:153], v[52:53] op_sel_hi:[1,0,1]
    v_pk_fma_f32 v[54:55], v[186:187], v[152:153], v[54:55] op_sel_hi:[1,0,1]
    v_pk_fma_f32 v[56:57], v[188:189], v[152:153], v[56:57] op_sel_hi:[1,0,1]
    v_pk_fma_f32 v[58:59], v[190:191], v[152:153], v[58:59] op_sel_hi:[1,0,1]
    v_pk_fma_f32 v[60:61], v[192:193], v[152:153], v[60:61] op_sel_hi:[1,0,1]
    v_pk_fma_f32 v[62:63], v[194:195], v[152:153], v[62:63] op_sel_hi:[1,0,1]
    v_pk_mul_f32 v[48:49], v[48:49], v[156:157] op_sel_hi:[1,0]
    v_pk_mul_f32 v[50:51], v[50:51], v[156:157] op_sel_hi:[1,0]
    v_pk_mul_f32 v[52:53], v[52:53], v[156:157] op_sel_hi:[1,0]
    v_pk_mul_f32 v[54:55], v[54:55], v[156:157] op_sel_hi:[1,0]
    v_pk_mul_f32 v[56:57], v[56:57], v[156:157] op_sel_hi:[1,0]
    v_pk_mul_f32 v[58:59], v[58:59], v[156:157] op_sel_hi:[1,0]
    v_pk_mul_f32 v[60:61], v[60:61], v[156:157] op_sel_hi:[1,0]
    v_pk_mul_f32 v[62:63], v[62:63], v[156:157] op_sel_hi:[1,0]
    s_waitcnt lgkmcnt(0)
    v_pk_fma_f32 v[80:81], v[196:197], v[162:163], v[80:81] op_sel_hi:[1,0,1]
    v_pk_fma_f32 v[82:83], v[198:199], v[162:163], v[82:83] op_sel_hi:[1,0,1]
    v_pk_fma_f32 v[84:85], v[200:201], v[162:163], v[84:85] op_sel_hi:[1,0,1]
    v_pk_fma_f32 v[86:87], v[202:203], v[162:163], v[86:87] op_sel_hi:[1,0,1]
    v_pk_fma_f32 v[88:89], v[204:205], v[162:163], v[88:89] op_sel_hi:[1,0,1]
    v_pk_fma_f32 v[90:91], v[206:207], v[162:163], v[90:91] op_sel_hi:[1,0,1]
    v_pk_fma_f32 v[92:93], v[208:209], v[162:163], v[92:93] op_sel_hi:[1,0,1]
    v_pk_fma_f32 v[94:95], v[210:211], v[162:163], v[94:95] op_sel_hi:[1,0,1]
    v_pk_mul_f32 v[80:81], v[80:81], v[212:213]
    v_pk_mul_f32 v[82:83], v[82:83], v[214:215]
    v_pk_mul_f32 v[84:85], v[84:85], v[216:217]
    v_pk_mul_f32 v[86:87], v[86:87], v[218:219]
    v_pk_mul_f32 v[88:89], v[88:89], v[220:221]
    v_pk_mul_f32 v[90:91], v[90:91], v[222:223]
    v_pk_mul_f32 v[92:93], v[92:93], v[224:225]
    v_pk_mul_f32 v[94:95], v[94:95], v[226:227]
    v_cvt_pk_bf16_f32 v236, v80, v81
    v_cvt_pk_bf16_f32 v237, v82, v83
    v_cvt_pk_bf16_f32 v238, v84, v85
    v_cvt_pk_bf16_f32 v239, v86, v87
    v_cvt_pk_bf16_f32 v240, v88, v89
    v_cvt_pk_bf16_f32 v241, v90, v91
    v_cvt_pk_bf16_f32 v242, v92, v93
    v_cvt_pk_bf16_f32 v243, v94, v95
    v_cvt_pk_bf16_f32 v196, v32, v33
    v_cvt_pk_bf16_f32 v197, v34, v35
    v_cvt_pk_bf16_f32 v198, v36, v37
    v_cvt_pk_bf16_f32 v199, v38, v39
    v_cvt_pk_bf16_f32 v200, v40, v41
    v_cvt_pk_bf16_f32 v201, v42, v43
    v_cvt_pk_bf16_f32 v202, v44, v45
    v_cvt_pk_bf16_f32 v203, v46, v47
    v_cvt_pk_bf16_f32 v204, v48, v49
    v_cvt_pk_bf16_f32 v205, v50, v51
    v_cvt_pk_bf16_f32 v206, v52, v53
    v_cvt_pk_bf16_f32 v207, v54, v55
    v_cvt_pk_bf16_f32 v208, v56, v57
    v_cvt_pk_bf16_f32 v209, v58, v59
    v_cvt_pk_bf16_f32 v210, v60, v61
    v_cvt_pk_bf16_f32 v211, v62, v63
    v_lshrrev_b32 v148, 5, v255
    v_bfe_u32 v149, v255, 2, 2
    v_lshl_add_u32 v148, v148, 2, v149
    v_lshlrev_b32 v148, 6, v148
    v_bfe_u32 v149, v255, 4, 1
    v_lshl_add_u32 v148, v149, 5, v148
    v_and_b32 v149, 3, v255
    v_lshl_add_u32 v149, v149, 3, v148
    s_lshl_b32 s39, s24, 11
    s_add_u32 s39, s39, 134144
    v_add_u32 v149, s39, v149
    ds_read_b64_tr_b16 v[212:213], v149 offset:0
    ds_read_b64_tr_b16 v[214:215], v149 offset:512
    ds_read_b64_tr_b16 v[216:217], v149 offset:1024
    ds_read_b64_tr_b16 v[218:219], v149 offset:1536
    v_bfe_u32 v144, v255, 2, 1
    v_lshrrev_b32 v145, 5, v255
    v_cmp_eq_u32 vcc, v144, v145
    v_bfe_u32 v146, v255, 3, 1
    v_lshlrev_b32 v146, 2, v146
    v_and_b32 v144, 3, v255
    v_add_u32 v146, v146, v144
    v_and_b32 v144, 1, v146
    v_lshlrev_b32 v144, 4, v144
    v_mov_b32 v147, 0x3f80
    v_lshlrev_b32 v147, v144, v147
    v_cndmask_b32 v147, 0, v147, vcc
    v_lshrrev_b32 v146, 1, v146
    v_bfe_u32 v145, v255, 4, 1
    v_lshl_add_u32 v146, v145, 2, v146
    v_cmp_eq_u32 vcc, 0, v146
    s_nop 1
    v_cndmask_b32 v220, 0, v147, vcc
    v_cmp_eq_u32 vcc, 1, v146
    s_nop 1
    v_cndmask_b32 v221, 0, v147, vcc
    v_cmp_eq_u32 vcc, 2, v146
    s_nop 1
    v_cndmask_b32 v222, 0, v147, vcc
    v_cmp_eq_u32 vcc, 3, v146
    s_nop 1
    v_cndmask_b32 v223, 0, v147, vcc
    v_cmp_eq_u32 vcc, 4, v146
    s_nop 1
    v_cndmask_b32 v224, 0, v147, vcc
    v_cmp_eq_u32 vcc, 5, v146
    s_nop 1
    v_cndmask_b32 v225, 0, v147, vcc
    v_cmp_eq_u32 vcc, 6, v146
    s_nop 1
    v_cndmask_b32 v226, 0, v147, vcc
    v_cmp_eq_u32 vcc, 7, v146
    s_nop 1
    v_cndmask_b32 v227, 0, v147, vcc
    v_cmp_eq_u32 vcc, 0, v145
    v_mov_b32 v147, 0x3f803f80
    s_nop 0
    v_cndmask_b32 v148, 0, v147, vcc
    v_sub_u32 v149, v147, v148
    v_mov_b32 v144, v148
    v_mov_b32 v158, v149
    v_mov_b32 v145, v148
    v_mov_b32 v159, v149
    v_mov_b32 v146, v148
    v_mov_b32 v160, v149
    v_mov_b32 v147, v148
    v_mov_b32 v161, v149
    s_waitcnt lgkmcnt(0)
    v_mfma_f32_32x32x16_bf16 v[32:47], v[212:215], v[196:199], 0
    v_mfma_f32_32x32x16_bf16 v[32:47], v[216:219], v[200:203], v[32:47]
    s_nop 11
    v_max3_f32 v246, v32, v33, v34
    v_min3_f32 v247, v32, v33, v34
    v_max3_f32 v246, v246, v35, v36
    v_min3_f32 v247, v247, v35, v36
    v_max3_f32 v246, v246, v37, v38
    v_min3_f32 v247, v247, v37, v38
    v_max3_f32 v246, v246, v39, v40
    v_min3_f32 v247, v247, v39, v40
    v_max3_f32 v246, v246, v41, v42
    v_min3_f32 v247, v247, v41, v42
    v_max3_f32 v246, v246, v43, v44
    v_min3_f32 v247, v247, v43, v44
    v_max3_f32 v246, v246, v45, v46
    v_min3_f32 v247, v247, v45, v46
    v_max_f32 v246, v246, v47
    v_min_f32 v247, v247, v47
    v_mov_b32 v248, v246
    v_mov_b32 v249, v247
    s_nop 1
    v_permlane32_swap_b32 v246, v248
    v_permlane32_swap_b32 v247, v249
    s_nop 1
    v_max_f32 v246, v246, v248
    v_min_f32 v247, v247, v249
    v_mul_f32 v246, s68, v246
    v_mul_f32 v247, s68, v247
    v_fma_f32 v48, -v32, s68, v247
    v_fma_f32 v49, -v33, s68, v247
    v_fma_f32 v50, -v34, s68, v247
    v_fma_f32 v51, -v35, s68, v247
    v_fma_f32 v52, -v36, s68, v247
    v_fma_f32 v53, -v37, s68, v247
    v_fma_f32 v54, -v38, s68, v247
    v_fma_f32 v55, -v39, s68, v247
    v_fma_f32 v56, -v40, s68, v247
    v_fma_f32 v57, -v41, s68, v247
    v_fma_f32 v58, -v42, s68, v247
    v_fma_f32 v59, -v43, s68, v247
    v_fma_f32 v60, -v44, s68, v247
    v_fma_f32 v61, -v45, s68, v247
    v_fma_f32 v62, -v46, s68, v247
    v_fma_f32 v63, -v47, s68, v247
    v_fma_f32 v32, v32, s68, -v246
    v_fma_f32 v33, v33, s68, -v246
    v_fma_f32 v34, v34, s68, -v246
    v_fma_f32 v35, v35, s68, -v246
    v_fma_f32 v36, v36, s68, -v246
    v_fma_f32 v37, v37, s68, -v246
    v_fma_f32 v38, v38, s68, -v246
    v_fma_f32 v39, v39, s68, -v246
    v_fma_f32 v40, v40, s68, -v246
    v_fma_f32 v41, v41, s68, -v246
    v_fma_f32 v42, v42, s68, -v246
    v_fma_f32 v43, v43, s68, -v246
    v_fma_f32 v44, v44, s68, -v246
    v_fma_f32 v45, v45, s68, -v246
    v_fma_f32 v46, v46, s68, -v246
    v_fma_f32 v47, v47, s68, -v246
    v_exp_f32 v48, v48
    v_exp_f32 v49, v49
    v_exp_f32 v50, v50
    v_exp_f32 v51, v51
    v_exp_f32 v52, v52
    v_exp_f32 v53, v53
    v_exp_f32 v54, v54
    v_exp_f32 v55, v55
    v_exp_f32 v56, v56
    v_exp_f32 v57, v57
    v_exp_f32 v58, v58
    v_exp_f32 v59, v59
    v_exp_f32 v60, v60
    v_exp_f32 v61, v61
    v_exp_f32 v62, v62
    v_exp_f32 v63, v63
    v_exp_f32 v32, v32
    v_exp_f32 v33, v33
    v_exp_f32 v34, v34
    v_exp_f32 v35, v35
    v_exp_f32 v36, v36
    v_exp_f32 v37, v37
    v_exp_f32 v38, v38
    v_exp_f32 v39, v39
    v_exp_f32 v40, v40
    v_exp_f32 v41, v41
    v_exp_f32 v42, v42
    v_exp_f32 v43, v43
    v_exp_f32 v44, v44
    v_exp_f32 v45, v45
    v_exp_f32 v46, v46
    v_exp_f32 v47, v47
    v_pk_add_f32 v[252:253], v[48:49], v[50:51]
    v_pk_add_f32 v[252:253], v[252:253], v[52:53]
    v_pk_add_f32 v[252:253], v[252:253], v[54:55]
    v_pk_add_f32 v[252:253], v[252:253], v[56:57]
    v_pk_add_f32 v[252:253], v[252:253], v[58:59]
    v_pk_add_f32 v[252:253], v[252:253], v[60:61]
    v_pk_add_f32 v[252:253], v[252:253], v[62:63]
    v_pk_add_f32 v[250:251], v[32:33], v[34:35]
    v_pk_add_f32 v[250:251], v[250:251], v[36:37]
    v_pk_add_f32 v[250:251], v[250:251], v[38:39]
    v_pk_add_f32 v[250:251], v[250:251], v[40:41]
    v_pk_add_f32 v[250:251], v[250:251], v[42:43]
    v_pk_add_f32 v[250:251], v[250:251], v[44:45]
    v_pk_add_f32 v[250:251], v[250:251], v[46:47]
    v_add_f32 v252, v252, v253
    v_add_f32 v250, v250, v251
    v_mov_b32 v248, v250
    v_mov_b32 v249, v252
    s_nop 1
    v_permlane32_swap_b32 v250, v248
    v_permlane32_swap_b32 v252, v249
    s_nop 1
    v_add_f32 v250, v250, v248
    v_add_f32 v252, v252, v249
    v_rcp_f32 v250, v250
    v_rcp_f32 v252, v252
    s_nop 0
    v_pk_mul_f32 v[32:33], v[32:33], v[250:251] op_sel_hi:[1,0]
    v_pk_mul_f32 v[34:35], v[34:35], v[250:251] op_sel_hi:[1,0]
    v_pk_mul_f32 v[36:37], v[36:37], v[250:251] op_sel_hi:[1,0]
    v_pk_mul_f32 v[38:39], v[38:39], v[250:251] op_sel_hi:[1,0]
    v_pk_mul_f32 v[40:41], v[40:41], v[250:251] op_sel_hi:[1,0]
    v_pk_mul_f32 v[42:43], v[42:43], v[250:251] op_sel_hi:[1,0]
    v_pk_mul_f32 v[44:45], v[44:45], v[250:251] op_sel_hi:[1,0]
    v_pk_mul_f32 v[46:47], v[46:47], v[250:251] op_sel_hi:[1,0]
    v_pk_mul_f32 v[48:49], v[48:49], v[252:253] op_sel_hi:[1,0]
    v_pk_mul_f32 v[50:51], v[50:51], v[252:253] op_sel_hi:[1,0]
    v_pk_mul_f32 v[52:53], v[52:53], v[252:253] op_sel_hi:[1,0]
    v_pk_mul_f32 v[54:55], v[54:55], v[252:253] op_sel_hi:[1,0]
    v_pk_mul_f32 v[56:57], v[56:57], v[252:253] op_sel_hi:[1,0]
    v_pk_mul_f32 v[58:59], v[58:59], v[252:253] op_sel_hi:[1,0]
    v_pk_mul_f32 v[60:61], v[60:61], v[252:253] op_sel_hi:[1,0]
    v_pk_mul_f32 v[62:63], v[62:63], v[252:253] op_sel_hi:[1,0]
    v_cvt_pk_bf16_f32 v164, v32, v33
    v_cvt_pk_bf16_f32 v165, v34, v35
    v_cvt_pk_bf16_f32 v166, v36, v37
    v_cvt_pk_bf16_f32 v167, v38, v39
    v_cvt_pk_bf16_f32 v168, v40, v41
    v_cvt_pk_bf16_f32 v169, v42, v43
    v_cvt_pk_bf16_f32 v170, v44, v45
    v_cvt_pk_bf16_f32 v171, v46, v47
    v_cvt_pk_bf16_f32 v172, v48, v49
    v_cvt_pk_bf16_f32 v173, v50, v51
    v_cvt_pk_bf16_f32 v174, v52, v53
    v_cvt_pk_bf16_f32 v175, v54, v55
    v_cvt_pk_bf16_f32 v176, v56, v57
    v_cvt_pk_bf16_f32 v177, v58, v59
    v_cvt_pk_bf16_f32 v178, v60, v61
    v_cvt_pk_bf16_f32 v179, v62, v63
    s_nop 1
    v_mfma_f32_32x32x16_bf16 v[96:111], v[164:167], v[220:223], 0
    v_mfma_f32_32x32x16_bf16 v[96:111], v[168:171], v[224:227], v[96:111]
    v_mfma_f32_32x32x16_bf16 v[112:127], v[172:175], v[220:223], 0
    v_mfma_f32_32x32x16_bf16 v[112:127], v[176:179], v[224:227], v[112:127]
    s_nop 10
    v_cvt_pk_bf16_f32 v128, v96, v97
    v_cvt_pk_bf16_f32 v129, v98, v99
    v_cvt_pk_bf16_f32 v130, v100, v101
    v_cvt_pk_bf16_f32 v131, v102, v103
    v_cvt_pk_bf16_f32 v132, v104, v105
    v_cvt_pk_bf16_f32 v133, v106, v107
    v_cvt_pk_bf16_f32 v134, v108, v109
    v_cvt_pk_bf16_f32 v135, v110, v111
    v_cvt_pk_bf16_f32 v136, v112, v113
    v_cvt_pk_bf16_f32 v137, v114, v115
    v_cvt_pk_bf16_f32 v138, v116, v117
    v_cvt_pk_bf16_f32 v139, v118, v119
    v_cvt_pk_bf16_f32 v140, v120, v121
    v_cvt_pk_bf16_f32 v141, v122, v123
    v_cvt_pk_bf16_f32 v142, v124, v125
    v_cvt_pk_bf16_f32 v143, v126, v127
    s_nop 1
    v_mfma_f32_32x32x16_bf16 v[64:79], v[128:131], v[228:231], 0
    v_mfma_f32_32x32x16_bf16 v[64:79], v[132:135], v[232:235], v[64:79]
    v_mfma_f32_32x32x16_bf16 v[80:95], v[136:139], v[228:231], 0
    v_mfma_f32_32x32x16_bf16 v[80:95], v[140:143], v[232:235], v[80:95]
    v_mfma_f32_32x32x16_bf16 v[180:195], v[128:131], v[144:147], 0
    v_mfma_f32_32x32x16_bf16 v[180:195], v[132:135], v[144:147], v[180:195]
    v_mfma_f32_32x32x16_bf16 v[180:195], v[136:139], v[158:161], v[180:195]
    v_mfma_f32_32x32x16_bf16 v[180:195], v[140:143], v[158:161], v[180:195]
    v_mfma_f32_32x32x16_bf16 v[32:47], v[212:215], v[204:207], 0
    v_mfma_f32_32x32x16_bf16 v[32:47], v[216:219], v[208:211], v[32:47]
    s_nop 11
    v_max3_f32 v246, v32, v33, v34
    v_min3_f32 v247, v32, v33, v34
    v_max3_f32 v246, v246, v35, v36
    v_min3_f32 v247, v247, v35, v36
    v_max3_f32 v246, v246, v37, v38
    v_min3_f32 v247, v247, v37, v38
    v_max3_f32 v246, v246, v39, v40
    v_min3_f32 v247, v247, v39, v40
    v_max3_f32 v246, v246, v41, v42
    v_min3_f32 v247, v247, v41, v42
    v_max3_f32 v246, v246, v43, v44
    v_min3_f32 v247, v247, v43, v44
    v_max3_f32 v246, v246, v45, v46
    v_min3_f32 v247, v247, v45, v46
    v_max_f32 v246, v246, v47
    v_min_f32 v247, v247, v47
    v_mov_b32 v248, v246
    v_mov_b32 v249, v247
    s_nop 1
    v_permlane32_swap_b32 v246, v248
    v_permlane32_swap_b32 v247, v249
    s_nop 1
    v_max_f32 v246, v246, v248
    v_min_f32 v247, v247, v249
    v_mul_f32 v246, s68, v246
    v_mul_f32 v247, s68, v247
    v_fma_f32 v48, -v32, s68, v247
    v_fma_f32 v49, -v33, s68, v247
    v_fma_f32 v50, -v34, s68, v247
    v_fma_f32 v51, -v35, s68, v247
    v_fma_f32 v52, -v36, s68, v247
    v_fma_f32 v53, -v37, s68, v247
    v_fma_f32 v54, -v38, s68, v247
    v_fma_f32 v55, -v39, s68, v247
    v_fma_f32 v56, -v40, s68, v247
    v_fma_f32 v57, -v41, s68, v247
    v_fma_f32 v58, -v42, s68, v247
    v_fma_f32 v59, -v43, s68, v247
    v_fma_f32 v60, -v44, s68, v247
    v_fma_f32 v61, -v45, s68, v247
    v_fma_f32 v62, -v46, s68, v247
    v_fma_f32 v63, -v47, s68, v247
    v_fma_f32 v32, v32, s68, -v246
    v_fma_f32 v33, v33, s68, -v246
    v_fma_f32 v34, v34, s68, -v246
    v_fma_f32 v35, v35, s68, -v246
    v_fma_f32 v36, v36, s68, -v246
    v_fma_f32 v37, v37, s68, -v246
    v_fma_f32 v38, v38, s68, -v246
    v_fma_f32 v39, v39, s68, -v246
    v_fma_f32 v40, v40, s68, -v246
    v_fma_f32 v41, v41, s68, -v246
    v_fma_f32 v42, v42, s68, -v246
    v_fma_f32 v43, v43, s68, -v246
    v_fma_f32 v44, v44, s68, -v246
    v_fma_f32 v45, v45, s68, -v246
    v_fma_f32 v46, v46, s68, -v246
    v_fma_f32 v47, v47, s68, -v246
    v_exp_f32 v48, v48
    v_exp_f32 v49, v49
    v_exp_f32 v50, v50
    v_exp_f32 v51, v51
    v_exp_f32 v52, v52
    v_exp_f32 v53, v53
    v_exp_f32 v54, v54
    v_exp_f32 v55, v55
    v_exp_f32 v56, v56
    v_exp_f32 v57, v57
    v_exp_f32 v58, v58
    v_exp_f32 v59, v59
    v_exp_f32 v60, v60
    v_exp_f32 v61, v61
    v_exp_f32 v62, v62
    v_exp_f32 v63, v63
    v_exp_f32 v32, v32
    v_exp_f32 v33, v33
    v_exp_f32 v34, v34
    v_exp_f32 v35, v35
    v_exp_f32 v36, v36
    v_exp_f32 v37, v37
    v_exp_f32 v38, v38
    v_exp_f32 v39, v39
    v_exp_f32 v40, v40
    v_exp_f32 v41, v41
    v_exp_f32 v42, v42
    v_exp_f32 v43, v43
    v_exp_f32 v44, v44
    v_exp_f32 v45, v45
    v_exp_f32 v46, v46
    v_exp_f32 v47, v47
    v_pk_add_f32 v[252:253], v[48:49], v[50:51]
    v_pk_add_f32 v[252:253], v[252:253], v[52:53]
    v_pk_add_f32 v[252:253], v[252:253], v[54:55]
    v_pk_add_f32 v[252:253], v[252:253], v[56:57]
    v_pk_add_f32 v[252:253], v[252:253], v[58:59]
    v_pk_add_f32 v[252:253], v[252:253], v[60:61]
    v_pk_add_f32 v[252:253], v[252:253], v[62:63]
    v_pk_add_f32 v[250:251], v[32:33], v[34:35]
    v_pk_add_f32 v[250:251], v[250:251], v[36:37]
    v_pk_add_f32 v[250:251], v[250:251], v[38:39]
    v_pk_add_f32 v[250:251], v[250:251], v[40:41]
    v_pk_add_f32 v[250:251], v[250:251], v[42:43]
    v_pk_add_f32 v[250:251], v[250:251], v[44:45]
    v_pk_add_f32 v[250:251], v[250:251], v[46:47]
    v_add_f32 v252, v252, v253
    v_add_f32 v250, v250, v251
    v_mov_b32 v248, v250
    v_mov_b32 v249, v252
    s_nop 1
    v_permlane32_swap_b32 v250, v248
    v_permlane32_swap_b32 v252, v249
    s_nop 1
    v_add_f32 v250, v250, v248
    v_add_f32 v252, v252, v249
    v_rcp_f32 v250, v250
    v_rcp_f32 v252, v252
    s_nop 0
    v_pk_mul_f32 v[32:33], v[32:33], v[250:251] op_sel_hi:[1,0]
    v_pk_mul_f32 v[34:35], v[34:35], v[250:251] op_sel_hi:[1,0]
    v_pk_mul_f32 v[36:37], v[36:37], v[250:251] op_sel_hi:[1,0]
    v_pk_mul_f32 v[38:39], v[38:39], v[250:251] op_sel_hi:[1,0]
    v_pk_mul_f32 v[40:41], v[40:41], v[250:251] op_sel_hi:[1,0]
    v_pk_mul_f32 v[42:43], v[42:43], v[250:251] op_sel_hi:[1,0]
    v_pk_mul_f32 v[44:45], v[44:45], v[250:251] op_sel_hi:[1,0]
    v_pk_mul_f32 v[46:47], v[46:47], v[250:251] op_sel_hi:[1,0]
    v_pk_mul_f32 v[48:49], v[48:49], v[252:253] op_sel_hi:[1,0]
    v_pk_mul_f32 v[50:51], v[50:51], v[252:253] op_sel_hi:[1,0]
    v_pk_mul_f32 v[52:53], v[52:53], v[252:253] op_sel_hi:[1,0]
    v_pk_mul_f32 v[54:55], v[54:55], v[252:253] op_sel_hi:[1,0]
    v_pk_mul_f32 v[56:57], v[56:57], v[252:253] op_sel_hi:[1,0]
    v_pk_mul_f32 v[58:59], v[58:59], v[252:253] op_sel_hi:[1,0]
    v_pk_mul_f32 v[60:61], v[60:61], v[252:253] op_sel_hi:[1,0]
    v_pk_mul_f32 v[62:63], v[62:63], v[252:253] op_sel_hi:[1,0]
    v_cvt_pk_bf16_f32 v164, v32, v33
    v_cvt_pk_bf16_f32 v165, v34, v35
    v_cvt_pk_bf16_f32 v166, v36, v37
    v_cvt_pk_bf16_f32 v167, v38, v39
    v_cvt_pk_bf16_f32 v168, v40, v41
    v_cvt_pk_bf16_f32 v169, v42, v43
    v_cvt_pk_bf16_f32 v170, v44, v45
    v_cvt_pk_bf16_f32 v171, v46, v47
    v_cvt_pk_bf16_f32 v172, v48, v49
    v_cvt_pk_bf16_f32 v173, v50, v51
    v_cvt_pk_bf16_f32 v174, v52, v53
    v_cvt_pk_bf16_f32 v175, v54, v55
    v_cvt_pk_bf16_f32 v176, v56, v57
    v_cvt_pk_bf16_f32 v177, v58, v59
    v_cvt_pk_bf16_f32 v178, v60, v61
    v_cvt_pk_bf16_f32 v179, v62, v63
    s_nop 1
    v_mfma_f32_32x32x16_bf16 v[96:111], v[164:167], v[220:223], 0
    v_mfma_f32_32x32x16_bf16 v[96:111], v[168:171], v[224:227], v[96:111]
    v_mfma_f32_32x32x16_bf16 v[112:127], v[172:175], v[220:223], 0
    v_mfma_f32_32x32x16_bf16 v[112:127], v[176:179], v[224:227], v[112:127]
    s_nop 10
    v_cvt_pk_bf16_f32 v128, v96, v97
    v_cvt_pk_bf16_f32 v129, v98, v99
    v_cvt_pk_bf16_f32 v130, v100, v101
    v_cvt_pk_bf16_f32 v131, v102, v103
    v_cvt_pk_bf16_f32 v132, v104, v105
    v_cvt_pk_bf16_f32 v133, v106, v107
    v_cvt_pk_bf16_f32 v134, v108, v109
    v_cvt_pk_bf16_f32 v135, v110, v111
    v_cvt_pk_bf16_f32 v136, v112, v113
    v_cvt_pk_bf16_f32 v137, v114, v115
    v_cvt_pk_bf16_f32 v138, v116, v117
    v_cvt_pk_bf16_f32 v139, v118, v119
    v_cvt_pk_bf16_f32 v140, v120, v121
    v_cvt_pk_bf16_f32 v141, v122, v123
    v_cvt_pk_bf16_f32 v142, v124, v125
    v_cvt_pk_bf16_f32 v143, v126, v127
    s_nop 1
    v_mfma_f32_32x32x16_bf16 v[64:79], v[128:131], v[236:239], v[64:79]
    v_mfma_f32_32x32x16_bf16 v[64:79], v[132:135], v[240:243], v[64:79]
    v_mfma_f32_32x32x16_bf16 v[80:95], v[136:139], v[236:239], v[80:95]
    v_mfma_f32_32x32x16_bf16 v[80:95], v[140:143], v[240:243], v[80:95]
    v_mfma_f32_32x32x16_bf16 v[180:195], v[128:131], v[144:147], v[180:195]
    v_mfma_f32_32x32x16_bf16 v[180:195], v[132:135], v[144:147], v[180:195]
    v_mfma_f32_32x32x16_bf16 v[180:195], v[136:139], v[158:161], v[180:195]
    v_mfma_f32_32x32x16_bf16 v[180:195], v[140:143], v[158:161], v[180:195]
    s_nop 15
    s_lshl_b32 s39, s24, 13
    s_add_u32 s39, s39, 138240
    v_add_u32 v148, s39, v254
    v_lshrrev_b32 v149, 4, v255
    v_lshlrev_b32 v149, 6, v149
    s_lshl_b32 s39, s24, 8
    s_add_u32 s39, s39, 154624
    v_add_u32 v149, s39, v149
    s_cmp_eq_u32 s23, 0
    s_cbranch_scc1 mA_red0
    ds_write_b128 v148, v[64:67] offset:0
    ds_write_b128 v148, v[68:71] offset:1024
    ds_write_b128 v148, v[72:75] offset:2048
    ds_write_b128 v148, v[76:79] offset:3072
    ds_write_b128 v148, v[80:83] offset:4096
    ds_write_b128 v148, v[84:87] offset:5120
    ds_write_b128 v148, v[88:91] offset:6144
    ds_write_b128 v148, v[92:95] offset:7168
    s_mov_b32 exec_lo, 0x00010001
    s_mov_b32 exec_hi, 0x00010001
    ds_write_b128 v149, v[180:183] offset:0
    ds_write_b128 v149, v[184:187] offset:16
    ds_write_b128 v149, v[188:191] offset:32
    ds_write_b128 v149, v[192:195] offset:48
    s_mov_b64 exec, -1
    s_waitcnt lgkmcnt(0)
    s_barrier
    s_branch mA_red1
mA_red0:
    s_barrier
    ds_read_b128 v[96:99], v148 offset:0
    ds_read_b128 v[100:103], v148 offset:1024
    ds_read_b128 v[104:107], v148 offset:2048
    ds_read_b128 v[108:111], v148 offset:3072
    ds_read_b128 v[112:115], v148 offset:4096
    ds_read_b128 v[116:119], v148 offset:5120
    ds_read_b128 v[120:123], v148 offset:6144
    ds_read_b128 v[124:127], v148 offset:7168
    ds_read_b128 v[128:131], v149 offset:0
    ds_read_b128 v[132:135], v149 offset:16
    ds_read_b128 v[136:139], v149 offset:32
    ds_read_b128 v[140:143], v149 offset:48
    s_waitcnt lgkmcnt(0)
    v_pk_add_f32 v[64:65], v[64:65], v[96:97]
    v_pk_add_f32 v[66:67], v[66:67], v[98:99]
    v_pk_add_f32 v[68:69], v[68:69], v[100:101]
    v_pk_add_f32 v[70:71], v[70:71], v[102:103]
    v_pk_add_f32 v[72:73], v[72:73], v[104:105]
    v_pk_add_f32 v[74:75], v[74:75], v[106:107]
    v_pk_add_f32 v[76:77], v[76:77], v[108:109]
    v_pk_add_f32 v[78:79], v[78:79], v[110:111]
    v_pk_add_f32 v[80:81], v[80:81], v[112:113]
    v_pk_add_f32 v[82:83], v[82:83], v[114:115]
    v_pk_add_f32 v[84:85], v[84:85], v[116:117]
    v_pk_add_f32 v[86:87], v[86:87], v[118:119]
    v_pk_add_f32 v[88:89], v[88:89], v[120:121]
    v_pk_add_f32 v[90:91], v[90:91], v[122:123]
    v_pk_add_f32 v[92:93], v[92:93], v[124:125]
    v_pk_add_f32 v[94:95], v[94:95], v[126:127]
    v_pk_add_f32 v[180:181], v[180:181], v[128:129]
    v_pk_add_f32 v[182:183], v[182:183], v[130:131]
    v_pk_add_f32 v[184:185], v[184:185], v[132:133]
    v_pk_add_f32 v[186:187], v[186:187], v[134:135]
    v_pk_add_f32 v[188:189], v[188:189], v[136:137]
    v_pk_add_f32 v[190:191], v[190:191], v[138:139]
    v_pk_add_f32 v[192:193], v[192:193], v[140:141]
    v_pk_add_f32 v[194:195], v[194:195], v[142:143]
    v_cvt_pk_bf16_f32 v96, v64, v65
    v_cvt_pk_bf16_f32 v97, v66, v67
    v_cvt_pk_bf16_f32 v98, v68, v69
    v_cvt_pk_bf16_f32 v99, v70, v71
    v_cvt_pk_bf16_f32 v100, v72, v73
    v_cvt_pk_bf16_f32 v101, v74, v75
    v_cvt_pk_bf16_f32 v102, v76, v77
    v_cvt_pk_bf16_f32 v103, v78, v79
    v_cvt_pk_bf16_f32 v104, v80, v81
    v_cvt_pk_bf16_f32 v105, v82, v83
    v_cvt_pk_bf16_f32 v106, v84, v85
    v_cvt_pk_bf16_f32 v107, v86, v87
    v_cvt_pk_bf16_f32 v108, v88, v89
    v_cvt_pk_bf16_f32 v109, v90, v91
    v_cvt_pk_bf16_f32 v110, v92, v93
    v_cvt_pk_bf16_f32 v111, v94, v95
    s_lshl_b32 s52, s50, 4
    s_add_u32 s52, s52, s20
    s_lshl_b32 s53, s52, 12
    s_add_u32 s53, s53, s63
    buffer_store_dwordx4 v[96:99], v254, s[8:11], s53 offen offset:0 sc1
    buffer_store_dwordx4 v[100:103], v254, s[8:11], s53 offen offset:1024 sc1
    buffer_store_dwordx4 v[104:107], v254, s[8:11], s53 offen offset:2048 sc1
    buffer_store_dwordx4 v[108:111], v254, s[8:11], s53 offen offset:3072 sc1
    s_lshl_b32 s53, s52, 8
    s_add_u32 s53, s53, s67
    v_bfe_u32 v148, v255, 4, 1
    v_lshlrev_b32 v148, 7, v148
    v_lshrrev_b32 v149, 5, v255
    v_lshl_add_u32 v148, v149, 6, v148
    s_mov_b32 exec_lo, 0x00010001
    s_mov_b32 exec_hi, 0x00010001
    buffer_store_dwordx4 v[180:183], v148, s[8:11], s53 offen offset:0 sc1
    buffer_store_dwordx4 v[184:187], v148, s[8:11], s53 offen offset:16 sc1
    buffer_store_dwordx4 v[188:191], v148, s[8:11], s53 offen offset:32 sc1
    buffer_store_dwordx4 v[192:195], v148, s[8:11], s53 offen offset:48 sc1
    s_mov_b64 exec, -1
    s_waitcnt vmcnt(0)
mA_red1:
    s_barrier
    v_lshrrev_b32 v149, 5, v255
    v_lshlrev_b32 v149, 4, v149
    s_lshl_b32 s39, s24, 7
    s_add_u32 s39, s39, s70
    v_add_u32 v149, s39, v149
    ds_read_b128 v[164:167], v149 offset:0
    ds_read_b128 v[168:171], v149 offset:32
    ds_read_b128 v[172:175], v149 offset:64
    ds_read_b128 v[176:179], v149 offset:96
    s_waitcnt lgkmcnt(0)
    v_pk_fma_f32 v[0:1], v[164:165], v[150:151], v[0:1] op_sel_hi:[1,0,1]
    v_pk_fma_f32 v[2:3], v[166:167], v[150:151], v[2:3] op_sel_hi:[1,0,1]
    v_pk_fma_f32 v[4:5], v[168:169], v[150:151], v[4:5] op_sel_hi:[1,0,1]
    v_pk_fma_f32 v[6:7], v[170:171], v[150:151], v[6:7] op_sel_hi:[1,0,1]
    v_pk_fma_f32 v[8:9], v[172:173], v[150:151], v[8:9] op_sel_hi:[1,0,1]
    v_pk_fma_f32 v[10:11], v[174:175], v[150:151], v[10:11] op_sel_hi:[1,0,1]
    v_pk_fma_f32 v[12:13], v[176:177], v[150:151], v[12:13] op_sel_hi:[1,0,1]
    v_pk_fma_f32 v[14:15], v[178:179], v[150:151], v[14:15] op_sel_hi:[1,0,1]
    v_pk_mul_f32 v[0:1], v[0:1], v[154:155] op_sel_hi:[1,0]
    v_pk_mul_f32 v[2:3], v[2:3], v[154:155] op_sel_hi:[1,0]
    v_pk_mul_f32 v[4:5], v[4:5], v[154:155] op_sel_hi:[1,0]
    v_pk_mul_f32 v[6:7], v[6:7], v[154:155] op_sel_hi:[1,0]
    v_pk_mul_f32 v[8:9], v[8:9], v[154:155] op_sel_hi:[1,0]
    v_pk_mul_f32 v[10:11], v[10:11], v[154:155] op_sel_hi:[1,0]
    v_pk_mul_f32 v[12:13], v[12:13], v[154:155] op_sel_hi:[1,0]
    v_pk_mul_f32 v[14:15], v[14:15], v[154:155] op_sel_hi:[1,0]
    v_pk_fma_f32 v[16:17], v[164:165], v[152:153], v[16:17] op_sel_hi:[1,0,1]
    v_pk_fma_f32 v[18:19], v[166:167], v[152:153], v[18:19] op_sel_hi:[1,0,1]
    v_pk_fma_f32 v[20:21], v[168:169], v[152:153], v[20:21] op_sel_hi:[1,0,1]
    v_pk_fma_f32 v[22:23], v[170:171], v[152:153], v[22:23] op_sel_hi:[1,0,1]
    v_pk_fma_f32 v[24:25], v[172:173], v[152:153], v[24:25] op_sel_hi:[1,0,1]
    v_pk_fma_f32 v[26:27], v[174:175], v[152:153], v[26:27] op_sel_hi:[1,0,1]
    v_pk_fma_f32 v[28:29], v[176:177], v[152:153], v[28:29] op_sel_hi:[1,0,1]
    v_pk_fma_f32 v[30:31], v[178:179], v[152:153], v[30:31] op_sel_hi:[1,0,1]
    v_pk_mul_f32 v[16:17], v[16:17], v[156:157] op_sel_hi:[1,0]
    v_pk_mul_f32 v[18:19], v[18:19], v[156:157] op_sel_hi:[1,0]
    v_pk_mul_f32 v[20:21], v[20:21], v[156:157] op_sel_hi:[1,0]
    v_pk_mul_f32 v[22:23], v[22:23], v[156:157] op_sel_hi:[1,0]
    v_pk_mul_f32 v[24:25], v[24:25], v[156:157] op_sel_hi:[1,0]
    v_pk_mul_f32 v[26:27], v[26:27], v[156:157] op_sel_hi:[1,0]
    v_pk_mul_f32 v[28:29], v[28:29], v[156:157] op_sel_hi:[1,0]
    v_pk_mul_f32 v[30:31], v[30:31], v[156:157] op_sel_hi:[1,0]
    v_cvt_pk_bf16_f32 v196, v0, v1
    v_cvt_pk_bf16_f32 v197, v2, v3
    v_cvt_pk_bf16_f32 v198, v4, v5
    v_cvt_pk_bf16_f32 v199, v6, v7
    v_cvt_pk_bf16_f32 v200, v8, v9
    v_cvt_pk_bf16_f32 v201, v10, v11
    v_cvt_pk_bf16_f32 v202, v12, v13
    v_cvt_pk_bf16_f32 v203, v14, v15
    v_cvt_pk_bf16_f32 v204, v16, v17
    v_cvt_pk_bf16_f32 v205, v18, v19
    v_cvt_pk_bf16_f32 v206, v20, v21
    v_cvt_pk_bf16_f32 v207, v22, v23
    v_cvt_pk_bf16_f32 v208, v24, v25
    v_cvt_pk_bf16_f32 v209, v26, v27
    v_cvt_pk_bf16_f32 v210, v28, v29
    v_cvt_pk_bf16_f32 v211, v30, v31
    s_nop 1
    v_mfma_f32_32x32x16_bf16 v[32:47], v[212:215], v[196:199], 0
    v_mfma_f32_32x32x16_bf16 v[32:47], v[216:219], v[200:203], v[32:47]
    s_nop 11
    v_max3_f32 v246, v32, v33, v34
    v_min3_f32 v247, v32, v33, v34
    v_max3_f32 v246, v246, v35, v36
    v_min3_f32 v247, v247, v35, v36
    v_max3_f32 v246, v246, v37, v38
    v_min3_f32 v247, v247, v37, v38
    v_max3_f32 v246, v246, v39, v40
    v_min3_f32 v247, v247, v39, v40
    v_max3_f32 v246, v246, v41, v42
    v_min3_f32 v247, v247, v41, v42
    v_max3_f32 v246, v246, v43, v44
    v_min3_f32 v247, v247, v43, v44
    v_max3_f32 v246, v246, v45, v46
    v_min3_f32 v247, v247, v45, v46
    v_max_f32 v246, v246, v47
    v_min_f32 v247, v247, v47
    v_mov_b32 v248, v246
    v_mov_b32 v249, v247
    s_nop 1
    v_permlane32_swap_b32 v246, v248
    v_permlane32_swap_b32 v247, v249
    s_nop 1
    v_max_f32 v246, v246, v248
    v_min_f32 v247, v247, v249
    v_mul_f32 v246, s68, v246
    v_mul_f32 v247, s68, v247
    v_fma_f32 v48, -v32, s68, v247
    v_fma_f32 v49, -v33, s68, v247
    v_fma_f32 v50, -v34, s68, v247
    v_fma_f32 v51, -v35, s68, v247
    v_fma_f32 v52, -v36, s68, v247
    v_fma_f32 v53, -v37, s68, v247
    v_fma_f32 v54, -v38, s68, v247
    v_fma_f32 v55, -v39, s68, v247
    v_fma_f32 v56, -v40, s68, v247
    v_fma_f32 v57, -v41, s68, v247
    v_fma_f32 v58, -v42, s68, v247
    v_fma_f32 v59, -v43, s68, v247
    v_fma_f32 v60, -v44, s68, v247
    v_fma_f32 v61, -v45, s68, v247
    v_fma_f32 v62, -v46, s68, v247
    v_fma_f32 v63, -v47, s68, v247
    v_fma_f32 v32, v32, s68, -v246
    v_fma_f32 v33, v33, s68, -v246
    v_fma_f32 v34, v34, s68, -v246
    v_fma_f32 v35, v35, s68, -v246
    v_fma_f32 v36, v36, s68, -v246
    v_fma_f32 v37, v37, s68, -v246
    v_fma_f32 v38, v38, s68, -v246
    v_fma_f32 v39, v39, s68, -v246
    v_fma_f32 v40, v40, s68, -v246
    v_fma_f32 v41, v41, s68, -v246
    v_fma_f32 v42, v42, s68, -v246
    v_fma_f32 v43, v43, s68, -v246
    v_fma_f32 v44, v44, s68, -v246
    v_fma_f32 v45, v45, s68, -v246
    v_fma_f32 v46, v46, s68, -v246
    v_fma_f32 v47, v47, s68, -v246
    v_exp_f32 v48, v48
    v_exp_f32 v49, v49
    v_exp_f32 v50, v50
    v_exp_f32 v51, v51
    v_exp_f32 v52, v52
    v_exp_f32 v53, v53
    v_exp_f32 v54, v54
    v_exp_f32 v55, v55
    v_exp_f32 v56, v56
    v_exp_f32 v57, v57
    v_exp_f32 v58, v58
    v_exp_f32 v59, v59
    v_exp_f32 v60, v60
    v_exp_f32 v61, v61
    v_exp_f32 v62, v62
    v_exp_f32 v63, v63
    v_exp_f32 v32, v32
    v_exp_f32 v33, v33
    v_exp_f32 v34, v34
    v_exp_f32 v35, v35
    v_exp_f32 v36, v36
    v_exp_f32 v37, v37
    v_exp_f32 v38, v38
    v_exp_f32 v39, v39
    v_exp_f32 v40, v40
    v_exp_f32 v41, v41
    v_exp_f32 v42, v42
    v_exp_f32 v43, v43
    v_exp_f32 v44, v44
    v_exp_f32 v45, v45
    v_exp_f32 v46, v46
    v_exp_f32 v47, v47
    v_pk_add_f32 v[252:253], v[48:49], v[50:51]
    v_pk_add_f32 v[252:253], v[252:253], v[52:53]
    v_pk_add_f32 v[252:253], v[252:253], v[54:55]
    v_pk_add_f32 v[252:253], v[252:253], v[56:57]
    v_pk_add_f32 v[252:253], v[252:253], v[58:59]
    v_pk_add_f32 v[252:253], v[252:253], v[60:61]
    v_pk_add_f32 v[252:253], v[252:253], v[62:63]
    v_pk_add_f32 v[250:251], v[32:33], v[34:35]
    v_pk_add_f32 v[250:251], v[250:251], v[36:37]
    v_pk_add_f32 v[250:251], v[250:251], v[38:39]
    v_pk_add_f32 v[250:251], v[250:251], v[40:41]
    v_pk_add_f32 v[250:251], v[250:251], v[42:43]
    v_pk_add_f32 v[250:251], v[250:251], v[44:45]
    v_pk_add_f32 v[250:251], v[250:251], v[46:47]
    v_add_f32 v252, v252, v253
    v_add_f32 v250, v250, v251
    v_mov_b32 v248, v250
    v_mov_b32 v249, v252
    s_nop 1
    v_permlane32_swap_b32 v250, v248
    v_permlane32_swap_b32 v252, v249
    s_nop 1
    v_add_f32 v250, v250, v248
    v_add_f32 v252, v252, v249
    v_rcp_f32 v250, v250
    v_rcp_f32 v252, v252
    s_nop 0
    v_pk_mul_f32 v[32:33], v[32:33], v[250:251] op_sel_hi:[1,0]
    v_pk_mul_f32 v[34:35], v[34:35], v[250:251] op_sel_hi:[1,0]
    v_pk_mul_f32 v[36:37], v[36:37], v[250:251] op_sel_hi:[1,0]
    v_pk_mul_f32 v[38:39], v[38:39], v[250:251] op_sel_hi:[1,0]
    v_pk_mul_f32 v[40:41], v[40:41], v[250:251] op_sel_hi:[1,0]
    v_pk_mul_f32 v[42:43], v[42:43], v[250:251] op_sel_hi:[1,0]
    v_pk_mul_f32 v[44:45], v[44:45], v[250:251] op_sel_hi:[1,0]
    v_pk_mul_f32 v[46:47], v[46:47], v[250:251] op_sel_hi:[1,0]
    v_pk_mul_f32 v[48:49], v[48:49], v[252:253] op_sel_hi:[1,0]
    v_pk_mul_f32 v[50:51], v[50:51], v[252:253] op_sel_hi:[1,0]
    v_pk_mul_f32 v[52:53], v[52:53], v[252:253] op_sel_hi:[1,0]
    v_pk_mul_f32 v[54:55], v[54:55], v[252:253] op_sel_hi:[1,0]
    v_pk_mul_f32 v[56:57], v[56:57], v[252:253] op_sel_hi:[1,0]
    v_pk_mul_f32 v[58:59], v[58:59], v[252:253] op_sel_hi:[1,0]
    v_pk_mul_f32 v[60:61], v[60:61], v[252:253] op_sel_hi:[1,0]
    v_pk_mul_f32 v[62:63], v[62:63], v[252:253] op_sel_hi:[1,0]
    v_cvt_pk_bf16_f32 v164, v32, v33
    v_cvt_pk_bf16_f32 v165, v34, v35
    v_cvt_pk_bf16_f32 v166, v36, v37
    v_cvt_pk_bf16_f32 v167, v38, v39
    v_cvt_pk_bf16_f32 v168, v40, v41
    v_cvt_pk_bf16_f32 v169, v42, v43
    v_cvt_pk_bf16_f32 v170, v44, v45
    v_cvt_pk_bf16_f32 v171, v46, v47
    v_cvt_pk_bf16_f32 v172, v48, v49
    v_cvt_pk_bf16_f32 v173, v50, v51
    v_cvt_pk_bf16_f32 v174, v52, v53
    v_cvt_pk_bf16_f32 v175, v54, v55
    v_cvt_pk_bf16_f32 v176, v56, v57
    v_cvt_pk_bf16_f32 v177, v58, v59
    v_cvt_pk_bf16_f32 v178, v60, v61
    v_cvt_pk_bf16_f32 v179, v62, v63
    v_mfma_f32_32x32x16_bf16 v[32:47], v[212:215], v[204:207], 0
    v_mfma_f32_32x32x16_bf16 v[32:47], v[216:219], v[208:211], v[32:47]
    s_nop 11
    v_max3_f32 v246, v32, v33, v34
    v_min3_f32 v247, v32, v33, v34
    v_max3_f32 v246, v246, v35, v36
    v_min3_f32 v247, v247, v35, v36
    v_max3_f32 v246, v246, v37, v38
    v_min3_f32 v247, v247, v37, v38
    v_max3_f32 v246, v246, v39, v40
    v_min3_f32 v247, v247, v39, v40
    v_max3_f32 v246, v246, v41, v42
    v_min3_f32 v247, v247, v41, v42
    v_max3_f32 v246, v246, v43, v44
    v_min3_f32 v247, v247, v43, v44
    v_max3_f32 v246, v246, v45, v46
    v_min3_f32 v247, v247, v45, v46
    v_max_f32 v246, v246, v47
    v_min_f32 v247, v247, v47
    v_mov_b32 v248, v246
    v_mov_b32 v249, v247
    s_nop 1
    v_permlane32_swap_b32 v246, v248
    v_permlane32_swap_b32 v247, v249
    s_nop 1
    v_max_f32 v246, v246, v248
    v_min_f32 v247, v247, v249
    v_mul_f32 v246, s68, v246
    v_mul_f32 v247, s68, v247
    v_fma_f32 v48, -v32, s68, v247
    v_fma_f32 v49, -v33, s68, v247
    v_fma_f32 v50, -v34, s68, v247
    v_fma_f32 v51, -v35, s68, v247
    v_fma_f32 v52, -v36, s68, v247
    v_fma_f32 v53, -v37, s68, v247
    v_fma_f32 v54, -v38, s68, v247
    v_fma_f32 v55, -v39, s68, v247
    v_fma_f32 v56, -v40, s68, v247
    v_fma_f32 v57, -v41, s68, v247
    v_fma_f32 v58, -v42, s68, v247
    v_fma_f32 v59, -v43, s68, v247
    v_fma_f32 v60, -v44, s68, v247
    v_fma_f32 v61, -v45, s68, v247
    v_fma_f32 v62, -v46, s68, v247
    v_fma_f32 v63, -v47, s68, v247
    v_fma_f32 v32, v32, s68, -v246
    v_fma_f32 v33, v33, s68, -v246
    v_fma_f32 v34, v34, s68, -v246
    v_fma_f32 v35, v35, s68, -v246
    v_fma_f32 v36, v36, s68, -v246
    v_fma_f32 v37, v37, s68, -v246
    v_fma_f32 v38, v38, s68, -v246
    v_fma_f32 v39, v39, s68, -v246
    v_fma_f32 v40, v40, s68, -v246
    v_fma_f32 v41, v41, s68, -v246
    v_fma_f32 v42, v42, s68, -v246
    v_fma_f32 v43, v43, s68, -v246
    v_fma_f32 v44, v44, s68, -v246
    v_fma_f32 v45, v45, s68, -v246
    v_fma_f32 v46, v46, s68, -v246
    v_fma_f32 v47, v47, s68, -v246
    v_exp_f32 v48, v48
    v_exp_f32 v49, v49
    v_exp_f32 v50, v50
    v_exp_f32 v51, v51
    v_exp_f32 v52, v52
    v_exp_f32 v53, v53
    v_exp_f32 v54, v54
    v_exp_f32 v55, v55
    v_exp_f32 v56, v56
    v_exp_f32 v57, v57
    v_exp_f32 v58, v58
    v_exp_f32 v59, v59
    v_exp_f32 v60, v60
    v_exp_f32 v61, v61
    v_exp_f32 v62, v62
    v_exp_f32 v63, v63
    v_exp_f32 v32, v32
    v_exp_f32 v33, v33
    v_exp_f32 v34, v34
    v_exp_f32 v35, v35
    v_exp_f32 v36, v36
    v_exp_f32 v37, v37
    v_exp_f32 v38, v38
    v_exp_f32 v39, v39
    v_exp_f32 v40, v40
    v_exp_f32 v41, v41
    v_exp_f32 v42, v42
    v_exp_f32 v43, v43
    v_exp_f32 v44, v44
    v_exp_f32 v45, v45
    v_exp_f32 v46, v46
    v_exp_f32 v47, v47
    v_pk_add_f32 v[252:253], v[48:49], v[50:51]
    v_pk_add_f32 v[252:253], v[252:253], v[52:53]
    v_pk_add_f32 v[252:253], v[252:253], v[54:55]
    v_pk_add_f32 v[252:253], v[252:253], v[56:57]
    v_pk_add_f32 v[252:253], v[252:253], v[58:59]
    v_pk_add_f32 v[252:253], v[252:253], v[60:61]
    v_pk_add_f32 v[252:253], v[252:253], v[62:63]
    v_pk_add_f32 v[250:251], v[32:33], v[34:35]
    v_pk_add_f32 v[250:251], v[250:251], v[36:37]
    v_pk_add_f32 v[250:251], v[250:251], v[38:39]
    v_pk_add_f32 v[250:251], v[250:251], v[40:41]
    v_pk_add_f32 v[250:251], v[250:251], v[42:43]
    v_pk_add_f32 v[250:251], v[250:251], v[44:45]
    v_pk_add_f32 v[250:251], v[250:251], v[46:47]
    v_add_f32 v252, v252, v253
    v_add_f32 v250, v250, v251
    v_mov_b32 v248, v250
    v_mov_b32 v249, v252
    s_nop 1
    v_permlane32_swap_b32 v250, v248
    v_permlane32_swap_b32 v252, v249
    s_nop 1
    v_add_f32 v250, v250, v248
    v_add_f32 v252, v252, v249
    v_rcp_f32 v250, v250
    v_rcp_f32 v252, v252
    s_nop 0
    v_pk_mul_f32 v[32:33], v[32:33], v[250:251] op_sel_hi:[1,0]
    v_pk_mul_f32 v[34:35], v[34:35], v[250:251] op_sel_hi:[1,0]
    v_pk_mul_f32 v[36:37], v[36:37], v[250:251] op_sel_hi:[1,0]
    v_pk_mul_f32 v[38:39], v[38:39], v[250:251] op_sel_hi:[1,0]
    v_pk_mul_f32 v[40:41], v[40:41], v[250:251] op_sel_hi:[1,0]
    v_pk_mul_f32 v[42:43], v[42:43], v[250:251] op_sel_hi:[1,0]
    v_pk_mul_f32 v[44:45], v[44:45], v[250:251] op_sel_hi:[1,0]
    v_pk_mul_f32 v[46:47], v[46:47], v[250:251] op_sel_hi:[1,0]
    v_pk_mul_f32 v[48:49], v[48:49], v[252:253] op_sel_hi:[1,0]
    v_pk_mul_f32 v[50:51], v[50:51], v[252:253] op_sel_hi:[1,0]
    v_pk_mul_f32 v[52:53], v[52:53], v[252:253] op_sel_hi:[1,0]
    v_pk_mul_f32 v[54:55], v[54:55], v[252:253] op_sel_hi:[1,0]
    v_pk_mul_f32 v[56:57], v[56:57], v[252:253] op_sel_hi:[1,0]
    v_pk_mul_f32 v[58:59], v[58:59], v[252:253] op_sel_hi:[1,0]
    v_pk_mul_f32 v[60:61], v[60:61], v[252:253] op_sel_hi:[1,0]
    v_pk_mul_f32 v[62:63], v[62:63], v[252:253] op_sel_hi:[1,0]
    v_cvt_pk_bf16_f32 v180, v32, v33
    v_cvt_pk_bf16_f32 v181, v34, v35
    v_cvt_pk_bf16_f32 v182, v36, v37
    v_cvt_pk_bf16_f32 v183, v38, v39
    v_cvt_pk_bf16_f32 v184, v40, v41
    v_cvt_pk_bf16_f32 v185, v42, v43
    v_cvt_pk_bf16_f32 v186, v44, v45
    v_cvt_pk_bf16_f32 v187, v46, v47
    v_cvt_pk_bf16_f32 v188, v48, v49
    v_cvt_pk_bf16_f32 v189, v50, v51
    v_cvt_pk_bf16_f32 v190, v52, v53
    v_cvt_pk_bf16_f32 v191, v54, v55
    v_cvt_pk_bf16_f32 v192, v56, v57
    v_cvt_pk_bf16_f32 v193, v58, v59
    v_cvt_pk_bf16_f32 v194, v60, v61
    v_cvt_pk_bf16_f32 v195, v62, v63
    s_barrier
kv_reduce:
    s_lshr_b32 s39, s22, 2
    s_lshl_b32 s39, s39, 16
    s_and_b32 s40, s22, 3
    s_lshl_b32 s40, s40, 10
    s_add_u32 s39, s39, s40
    s_lshl_b32 s41, s21, 17
    s_add_u32 s39, s39, s41
    s_add_u32 s39, s39, s63
    buffer_load_dwordx4 v[64:67], v254, s[8:11], s39 offen sc1
    s_add_u32 s39, s39, 4096
    buffer_load_dwordx4 v[68:71], v254, s[8:11], s39 offen sc1
    s_add_u32 s39, s39, 4096
    buffer_load_dwordx4 v[72:75], v254, s[8:11], s39 offen sc1
    s_add_u32 s39, s39, 4096
    buffer_load_dwordx4 v[76:79], v254, s[8:11], s39 offen sc1
    s_add_u32 s39, s39, 4096
    buffer_load_dwordx4 v[80:83], v254, s[8:11], s39 offen sc1
    s_add_u32 s39, s39, 4096
    buffer_load_dwordx4 v[84:87], v254, s[8:11], s39 offen sc1
    s_add_u32 s39, s39, 4096
    buffer_load_dwordx4 v[88:91], v254, s[8:11], s39 offen sc1
    s_add_u32 s39, s39, 4096
    buffer_load_dwordx4 v[92:95], v254, s[8:11], s39 offen sc1
    s_add_u32 s39, s39, 4096
    buffer_load_dwordx4 v[96:99], v254, s[8:11], s39 offen sc1
    s_add_u32 s39, s39, 4096
    buffer_load_dwordx4 v[100:103], v254, s[8:11], s39 offen sc1
    s_add_u32 s39, s39, 4096
    buffer_load_dwordx4 v[104:107], v254, s[8:11], s39 offen sc1
    s_add_u32 s39, s39, 4096
    buffer_load_dwordx4 v[108:111], v254, s[8:11], s39 offen sc1
    s_add_u32 s39, s39, 4096
    buffer_load_dwordx4 v[112:115], v254, s[8:11], s39 offen sc1
    s_add_u32 s39, s39, 4096
    buffer_load_dwordx4 v[116:119], v254, s[8:11], s39 offen sc1
    s_add_u32 s39, s39, 4096
    buffer_load_dwordx4 v[120:123], v254, s[8:11], s39 offen sc1
    s_add_u32 s39, s39, 4096
    buffer_load_dwordx4 v[124:127], v254, s[8:11], s39 offen sc1
    s_cmp_lt_u32 s22, 2
    s_cbranch_scc0 kvr_nz
    s_lshl_b32 s39, s21, 1
    s_add_u32 s39, s39, s22
    s_lshl_b32 s39, s39, 12
    s_add_u32 s39, s39, s67
    v_lshlrev_b32 v143, 2, v255
    buffer_load_dword v144, v143, s[8:11], s39 offen offset:0 sc1
    buffer_load_dword v145, v143, s[8:11], s39 offen offset:256 sc1
    buffer_load_dword v146, v143, s[8:11], s39 offen offset:512 sc1
    buffer_load_dword v147, v143, s[8:11], s39 offen offset:768 sc1
    buffer_load_dword v148, v143, s[8:11], s39 offen offset:1024 sc1
    buffer_load_dword v149, v143, s[8:11], s39 offen offset:1280 sc1
    buffer_load_dword v150, v143, s[8:11], s39 offen offset:1536 sc1
    buffer_load_dword v151, v143, s[8:11], s39 offen offset:1792 sc1
    buffer_load_dword v152, v143, s[8:11], s39 offen offset:2048 sc1
    buffer_load_dword v153, v143, s[8:11], s39 offen offset:2304 sc1
    buffer_load_dword v154, v143, s[8:11], s39 offen offset:2560 sc1
    buffer_load_dword v155, v143, s[8:11], s39 offen offset:2816 sc1
    buffer_load_dword v156, v143, s[8:11], s39 offen offset:3072 sc1
    buffer_load_dword v157, v143, s[8:11], s39 offen offset:3328 sc1
    buffer_load_dword v158, v143, s[8:11], s39 offen offset:3584 sc1
    buffer_load_dword v159, v143, s[8:11], s39 offen offset:3840 sc1
    s_waitcnt vmcnt(0)
    v_add_f32 v144, v144, v145
    v_add_f32 v144, v144, v146
    v_add_f32 v144, v144, v147
    v_add_f32 v144, v144, v148
    v_add_f32 v144, v144, v149
    v_add_f32 v144, v144, v150
    v_add_f32 v144, v144, v151
    v_add_f32 v144, v144, v152
    v_add_f32 v144, v144, v153
    v_add_f32 v144, v144, v154
    v_add_f32 v144, v144, v155
    v_add_f32 v144, v144, v156
    v_add_f32 v144, v144, v157
    v_add_f32 v144, v144, v158
    v_add_f32 v144, v144, v159
    v_cvt_pk_bf16_f32 v144, v144, v144
    v_lshrrev_b32 v145, 5, v255
    v_bfe_u32 v146, v255, 3, 1
    v_lshl_add_u32 v145, v145, 1, v146
    v_bfe_u32 v146, v255, 4, 1
    v_lshl_add_u32 v145, v145, 1, v146
    v_and_b32 v146, 7, v255
    v_lshl_add_u32 v145, v145, 3, v146
    v_lshlrev_b32 v145, 1, v145
    s_lshl_b32 s39, s22, 7
    s_add_u32 s39, s39, 146432
    v_add_u32 v145, s39, v145
    ds_write_b16 v145, v144
kvr_nz:
    v_mov_b32 v140, 0x3f80
    v_mov_b32 v141, 0x3f800000
    v_mov_b32 v128, 0
    v_mov_b32 v129, 0
    v_mov_b32 v130, 0
    v_mov_b32 v131, 0
    v_mov_b32 v132, 0
    v_mov_b32 v133, 0
    v_mov_b32 v134, 0
    v_mov_b32 v135, 0
    s_waitcnt vmcnt(15)
    v_dot2c_f32_bf16 v128, v64, v140
    v_dot2c_f32_bf16 v129, v64, v141
    v_dot2c_f32_bf16 v130, v65, v140
    v_dot2c_f32_bf16 v131, v65, v141
    v_dot2c_f32_bf16 v132, v66, v140
    v_dot2c_f32_bf16 v133, v66, v141
    v_dot2c_f32_bf16 v134, v67, v140
    v_dot2c_f32_bf16 v135, v67, v141
    s_waitcnt vmcnt(14)
    v_dot2c_f32_bf16 v128, v68, v140
    v_dot2c_f32_bf16 v129, v68, v141
    v_dot2c_f32_bf16 v130, v69, v140
    v_dot2c_f32_bf16 v131, v69, v141
    v_dot2c_f32_bf16 v132, v70, v140
    v_dot2c_f32_bf16 v133, v70, v141
    v_dot2c_f32_bf16 v134, v71, v140
    v_dot2c_f32_bf16 v135, v71, v141
    s_waitcnt vmcnt(13)
    v_dot2c_f32_bf16 v128, v72, v140
    v_dot2c_f32_bf16 v129, v72, v141
    v_dot2c_f32_bf16 v130, v73, v140
    v_dot2c_f32_bf16 v131, v73, v141
    v_dot2c_f32_bf16 v132, v74, v140
    v_dot2c_f32_bf16 v133, v74, v141
    v_dot2c_f32_bf16 v134, v75, v140
    v_dot2c_f32_bf16 v135, v75, v141
    s_waitcnt vmcnt(12)
    v_dot2c_f32_bf16 v128, v76, v140
    v_dot2c_f32_bf16 v129, v76, v141
    v_dot2c_f32_bf16 v130, v77, v140
    v_dot2c_f32_bf16 v131, v77, v141
    v_dot2c_f32_bf16 v132, v78, v140
    v_dot2c_f32_bf16 v133, v78, v141
    v_dot2c_f32_bf16 v134, v79, v140
    v_dot2c_f32_bf16 v135, v79, v141
    s_waitcnt vmcnt(11)
    v_dot2c_f32_bf16 v128, v80, v140
    v_dot2c_f32_bf16 v129, v80, v141
    v_dot2c_f32_bf16 v130, v81, v140
    v_dot2c_f32_bf16 v131, v81, v141
    v_dot2c_f32_bf16 v132, v82, v140
    v_dot2c_f32_bf16 v133, v82, v141
    v_dot2c_f32_bf16 v134, v83, v140
    v_dot2c_f32_bf16 v135, v83, v141
    s_waitcnt vmcnt(10)
    v_dot2c_f32_bf16 v128, v84, v140
    v_dot2c_f32_bf16 v129, v84, v141
    v_dot2c_f32_bf16 v130, v85, v140
    v_dot2c_f32_bf16 v131, v85, v141
    v_dot2c_f32_bf16 v132, v86, v140
    v_dot2c_f32_bf16 v133, v86, v141
    v_dot2c_f32_bf16 v134, v87, v140
    v_dot2c_f32_bf16 v135, v87, v141
    s_waitcnt vmcnt(9)
    v_dot2c_f32_bf16 v128, v88, v140
    v_dot2c_f32_bf16 v129, v88, v141
    v_dot2c_f32_bf16 v130, v89, v140
    v_dot2c_f32_bf16 v131, v89, v141
    v_dot2c_f32_bf16 v132, v90, v140
    v_dot2c_f32_bf16 v133, v90, v141
    v_dot2c_f32_bf16 v134, v91, v140
    v_dot2c_f32_bf16 v135, v91, v141
    s_waitcnt vmcnt(8)
    v_dot2c_f32_bf16 v128, v92, v140
    v_dot2c_f32_bf16 v129, v92, v141
    v_dot2c_f32_bf16 v130, v93, v140
    v_dot2c_f32_bf16 v131, v93, v141
    v_dot2c_f32_bf16 v132, v94, v140
    v_dot2c_f32_bf16 v133, v94, v141
    v_dot2c_f32_bf16 v134, v95, v140
    v_dot2c_f32_bf16 v135, v95, v141
    s_waitcnt vmcnt(7)
    v_dot2c_f32_bf16 v128, v96, v140
    v_dot2c_f32_bf16 v129, v96, v141
    v_dot2c_f32_bf16 v130, v97, v140
    v_dot2c_f32_bf16 v131, v97, v141
    v_dot2c_f32_bf16 v132, v98, v140
    v_dot2c_f32_bf16 v133, v98, v141
    v_dot2c_f32_bf16 v134, v99, v140
    v_dot2c_f32_bf16 v135, v99, v141
    s_waitcnt vmcnt(6)
    v_dot2c_f32_bf16 v128, v100, v140
    v_dot2c_f32_bf16 v129, v100, v141
    v_dot2c_f32_bf16 v130, v101, v140
    v_dot2c_f32_bf16 v131, v101, v141
    v_dot2c_f32_bf16 v132, v102, v140
    v_dot2c_f32_bf16 v133, v102, v141
    v_dot2c_f32_bf16 v134, v103, v140
    v_dot2c_f32_bf16 v135, v103, v141
    s_waitcnt vmcnt(5)
    v_dot2c_f32_bf16 v128, v104, v140
    v_dot2c_f32_bf16 v129, v104, v141
    v_dot2c_f32_bf16 v130, v105, v140
    v_dot2c_f32_bf16 v131, v105, v141
    v_dot2c_f32_bf16 v132, v106, v140
    v_dot2c_f32_bf16 v133, v106, v141
    v_dot2c_f32_bf16 v134, v107, v140
    v_dot2c_f32_bf16 v135, v107, v141
    s_waitcnt vmcnt(4)
    v_dot2c_f32_bf16 v128, v108, v140
    v_dot2c_f32_bf16 v129, v108, v141
    v_dot2c_f32_bf16 v130, v109, v140
    v_dot2c_f32_bf16 v131, v109, v141
    v_dot2c_f32_bf16 v132, v110, v140
    v_dot2c_f32_bf16 v133, v110, v141
    v_dot2c_f32_bf16 v134, v111, v140
    v_dot2c_f32_bf16 v135, v111, v141
    s_waitcnt vmcnt(3)
    v_dot2c_f32_bf16 v128, v112, v140
    v_dot2c_f32_bf16 v129, v112, v141
    v_dot2c_f32_bf16 v130, v113, v140
    v_dot2c_f32_bf16 v131, v113, v141
    v_dot2c_f32_bf16 v132, v114, v140
    v_dot2c_f32_bf16 v133, v114, v141
    v_dot2c_f32_bf16 v134, v115, v140
    v_dot2c_f32_bf16 v135, v115, v141
    s_waitcnt vmcnt(2)
    v_dot2c_f32_bf16 v128, v116, v140
    v_dot2c_f32_bf16 v129, v116, v141
    v_dot2c_f32_bf16 v130, v117, v140
    v_dot2c_f32_bf16 v131, v117, v141
    v_dot2c_f32_bf16 v132, v118, v140
    v_dot2c_f32_bf16 v133, v118, v141
    v_dot2c_f32_bf16 v134, v119, v140
    v_dot2c_f32_bf16 v135, v119, v141
    s_waitcnt vmcnt(1)
    v_dot2c_f32_bf16 v128, v120, v140
    v_dot2c_f32_bf16 v129, v120, v141
    v_dot2c_f32_bf16 v130, v121, v140
    v_dot2c_f32_bf16 v131, v121, v141
    v_dot2c_f32_bf16 v132, v122, v140
    v_dot2c_f32_bf16 v133, v122, v141
    v_dot2c_f32_bf16 v134, v123, v140
    v_dot2c_f32_bf16 v135, v123, v141
    s_waitcnt vmcnt(0)
    v_dot2c_f32_bf16 v128, v124, v140
    v_dot2c_f32_bf16 v129, v124, v141
    v_dot2c_f32_bf16 v130, v125, v140
    v_dot2c_f32_bf16 v131, v125, v141
    v_dot2c_f32_bf16 v132, v126, v140
    v_dot2c_f32_bf16 v133, v126, v141
    v_dot2c_f32_bf16 v134, v127, v140
    v_dot2c_f32_bf16 v135, v127, v141
    s_nop 2
    v_cvt_pk_bf16_f32 v136, v128, v129
    v_cvt_pk_bf16_f32 v137, v130, v131
    v_cvt_pk_bf16_f32 v138, v132, v133
    v_cvt_pk_bf16_f32 v139, v134, v135
    s_lshl_b32 s39, s22, 10
    s_add_u32 s39, s39, 138240
    v_add_u32 v142, s39, v254
    ds_write_b128 v142, v[136:139]
    s_waitcnt lgkmcnt(0)
    s_barrier
    s_cmp_lt_u32 s22, 4
    s_cbranch_scc0 l_A2
    s_lshl_b32 s39, s24, 12
    s_add_u32 s39, s39, 138240
    v_add_u32 v148, s39, v254
    ds_read_b128 v[64:67], v148 offset:0
    ds_read_b128 v[68:71], v148 offset:1024
    ds_read_b128 v[72:75], v148 offset:2048
    ds_read_b128 v[76:79], v148 offset:3072
    v_lshrrev_b32 v149, 5, v255
    v_lshlrev_b32 v149, 4, v149
    s_lshl_b32 s39, s24, 7
    s_add_u32 s39, s39, 146432
    v_add_u32 v149, s39, v149
    ds_read_b128 v[80:83], v149 offset:0
    ds_read_b128 v[84:87], v149 offset:32
    ds_read_b128 v[88:91], v149 offset:64
    ds_read_b128 v[92:95], v149 offset:96
    s_lshl_b32 s50, s21, 1
    s_add_u32 s50, s50, s24
    s_lshl_b32 s51, s20, 2
    s_lshl_b32 s39, s23, 1
    s_add_u32 s51, s51, s39
    s_lshl_b32 s52, s51, 16
    s_lshl_b32 s53, s50, 11
    s_add_u32 s52, s52, s53
    s_add_u32 s52, s52, s62
    s_waitcnt lgkmcnt(0)
    v_mfma_f32_32x32x16_bf16 v[112:127], v[80:83], v[164:167], 0
    v_mfma_f32_32x32x16_bf16 v[112:127], v[84:87], v[168:171], v[112:127]
    v_mfma_f32_32x32x16_bf16 v[112:127], v[88:91], v[172:175], v[112:127]
    v_mfma_f32_32x32x16_bf16 v[112:127], v[92:95], v[176:179], v[112:127]
    v_mfma_f32_32x32x16_bf16 v[96:111], v[64:67], v[164:167], 0
    v_mfma_f32_32x32x16_bf16 v[96:111], v[68:71], v[168:171], v[96:111]
    v_mfma_f32_32x32x16_bf16 v[96:111], v[72:75], v[172:175], v[96:111]
    v_mfma_f32_32x32x16_bf16 v[96:111], v[76:79], v[176:179], v[96:111]
    v_mfma_f32_32x32x16_bf16 v[144:159], v[80:83], v[180:183], 0
    v_mfma_f32_32x32x16_bf16 v[144:159], v[84:87], v[184:187], v[144:159]
    v_mfma_f32_32x32x16_bf16 v[144:159], v[88:91], v[188:191], v[144:159]
    v_mfma_f32_32x32x16_bf16 v[144:159], v[92:95], v[192:195], v[144:159]
    v_mfma_f32_32x32x16_bf16 v[128:143], v[64:67], v[180:183], 0
    v_mfma_f32_32x32x16_bf16 v[128:143], v[68:71], v[184:187], v[128:143]
    v_mfma_f32_32x32x16_bf16 v[128:143], v[72:75], v[188:191], v[128:143]
    v_mfma_f32_32x32x16_bf16 v[128:143], v[76:79], v[192:195], v[128:143]
    s_nop 1
    v_add_f32 v246, 0x358637bd, v112
    v_rcp_f32 v246, v246
    s_nop 0
    v_pk_mul_f32 v[96:97], v[96:97], v[246:247] op_sel_hi:[1,0]
    v_pk_mul_f32 v[98:99], v[98:99], v[246:247] op_sel_hi:[1,0]
    v_pk_mul_f32 v[100:101], v[100:101], v[246:247] op_sel_hi:[1,0]
    v_pk_mul_f32 v[102:103], v[102:103], v[246:247] op_sel_hi:[1,0]
    v_pk_mul_f32 v[104:105], v[104:105], v[246:247] op_sel_hi:[1,0]
    v_pk_mul_f32 v[106:107], v[106:107], v[246:247] op_sel_hi:[1,0]
    v_pk_mul_f32 v[108:109], v[108:109], v[246:247] op_sel_hi:[1,0]
    v_pk_mul_f32 v[110:111], v[110:111], v[246:247] op_sel_hi:[1,0]
    v_cvt_pk_bf16_f32 v196, v96, v97
    v_cvt_pk_bf16_f32 v197, v98, v99
    v_cvt_pk_bf16_f32 v198, v100, v101
    v_cvt_pk_bf16_f32 v199, v102, v103
    v_cvt_pk_bf16_f32 v200, v104, v105
    v_cvt_pk_bf16_f32 v201, v106, v107
    v_cvt_pk_bf16_f32 v202, v108, v109
    v_cvt_pk_bf16_f32 v203, v110, v111
    s_add_u32 s53, s52, 0
    buffer_store_dwordx4 v[196:199], v254, s[8:11], s53 offen sc1
    buffer_store_dwordx4 v[200:203], v254, s[8:11], s53 offen offset:1024 sc1
    s_nop 7
    v_add_f32 v246, 0x358637bd, v144
    v_rcp_f32 v246, v246
    s_nop 0
    v_pk_mul_f32 v[128:129], v[128:129], v[246:247] op_sel_hi:[1,0]
    v_pk_mul_f32 v[130:131], v[130:131], v[246:247] op_sel_hi:[1,0]
    v_pk_mul_f32 v[132:133], v[132:133], v[246:247] op_sel_hi:[1,0]
    v_pk_mul_f32 v[134:135], v[134:135], v[246:247] op_sel_hi:[1,0]
    v_pk_mul_f32 v[136:137], v[136:137], v[246:247] op_sel_hi:[1,0]
    v_pk_mul_f32 v[138:139], v[138:139], v[246:247] op_sel_hi:[1,0]
    v_pk_mul_f32 v[140:141], v[140:141], v[246:247] op_sel_hi:[1,0]
    v_pk_mul_f32 v[142:143], v[142:143], v[246:247] op_sel_hi:[1,0]
    v_cvt_pk_bf16_f32 v204, v128, v129
    v_cvt_pk_bf16_f32 v205, v130, v131
    v_cvt_pk_bf16_f32 v206, v132, v133
    v_cvt_pk_bf16_f32 v207, v134, v135
    v_cvt_pk_bf16_f32 v208, v136, v137
    v_cvt_pk_bf16_f32 v209, v138, v139
    v_cvt_pk_bf16_f32 v210, v140, v141
    v_cvt_pk_bf16_f32 v211, v142, v143
    s_add_u32 s53, s52, 65536
    buffer_store_dwordx4 v[204:207], v254, s[8:11], s53 offen sc1
    buffer_store_dwordx4 v[208:211], v254, s[8:11], s53 offen offset:1024 sc1
    s_waitcnt vmcnt(0)
    s_branch m_f1
l_A2:
    s_barrier
    s_waitcnt vmcnt(0)
    s_barrier
    s_branch l_p3
m_B:
    v_and_b32 v148, 31, v255
    s_lshl_b32 s39, s23, 8
    v_lshlrev_b32 v148, 2, v148
    v_add_u32 v148, s39, v148
    v_add_u32 v148, 131072, v148
    ds_read_b32 v150, v148 offset:0
    ds_read_b32 v154, v148 offset:512
    ds_read_b32 v152, v148 offset:128
    ds_read_b32 v156, v148 offset:640
    v_lshrrev_b32 v149, 5, v255
    v_lshlrev_b32 v149, 4, v149
    s_lshl_b32 s39, s24, 7
    s_add_u32 s39, s39, s70
    v_add_u32 v149, s39, v149
    ds_read_b128 v[180:183], v149 offset:256
    ds_read_b128 v[184:187], v149 offset:288
    ds_read_b128 v[188:191], v149 offset:320
    ds_read_b128 v[192:195], v149 offset:352
    v_and_b32 v145, 31, v255
    v_lshlrev_b32 v145, 2, v145
    s_lshl_b32 s39, s24, 7
    s_add_u32 s39, s39, s70
    v_add_u32 v145, s39, v145
    ds_read_b32 v162, v145 offset:512
    v_lshrrev_b32 v144, 5, v255
    v_lshlrev_b32 v144, 4, v144
    s_lshl_b32 s39, s23, 8
    v_add_u32 v144, s39, v144
    v_add_u32 v144, 131072, v144
    ds_read_b128 v[196:199], v144 offset:0
    ds_read_b128 v[212:215], v144 offset:512
    ds_read_b128 v[200:203], v144 offset:32
    ds_read_b128 v[216:219], v144 offset:544
    ds_read_b128 v[204:207], v144 offset:64
    ds_read_b128 v[220:223], v144 offset:576
    ds_read_b128 v[208:211], v144 offset:96
    ds_read_b128 v[224:227], v144 offset:608
    v_lshrrev_b32 v149, 5, v255
    v_lshlrev_b32 v149, 4, v149
    s_lshl_b32 s39, s24, 7
    s_add_u32 s39, s39, s70
    v_add_u32 v149, s39, v149
    ds_read_b128 v[164:167], v149 offset:0
    ds_read_b128 v[168:171], v149 offset:32
    ds_read_b128 v[172:175], v149 offset:64
    ds_read_b128 v[176:179], v149 offset:96
    s_lshl_b32 s50, s21, 1
    s_add_u32 s50, s50, s24
    s_lshl_b32 s51, s20, 2
    s_lshl_b32 s39, s23, 1
    s_add_u32 s51, s51, s39
    s_lshl_b32 s52, s50, 6
    s_add_u32 s52, s52, s51
    s_lshl_b32 s52, s52, 12
    s_add_u32 s52, s52, s63
    s_lshl_b32 s39, s24, 16
    s_lshl_b32 s40, s23, 13
    s_add_u32 s39, s39, s40
    v_add_u32 v149, s39, v254
    s_waitcnt lgkmcnt(0)
    v_pk_fma_f32 v[32:33], v[180:181], v[150:151], v[32:33] op_sel_hi:[1,0,1]
    v_pk_fma_f32 v[34:35], v[182:183], v[150:151], v[34:35] op_sel_hi:[1,0,1]
    v_pk_fma_f32 v[36:37], v[184:185], v[150:151], v[36:37] op_sel_hi:[1,0,1]
    v_pk_fma_f32 v[38:39], v[186:187], v[150:151], v[38:39] op_sel_hi:[1,0,1]
    v_pk_fma_f32 v[40:41], v[188:189], v[150:151], v[40:41] op_sel_hi:[1,0,1]
    v_pk_fma_f32 v[42:43], v[190:191], v[150:151], v[42:43] op_sel_hi:[1,0,1]
    v_pk_fma_f32 v[44:45], v[192:193], v[150:151], v[44:45] op_sel_hi:[1,0,1]
    v_pk_fma_f32 v[46:47], v[194:195], v[150:151], v[46:47] op_sel_hi:[1,0,1]
    v_pk_mul_f32 v[32:33], v[32:33], v[154:155] op_sel_hi:[1,0]
    v_pk_mul_f32 v[34:35], v[34:35], v[154:155] op_sel_hi:[1,0]
    v_pk_mul_f32 v[36:37], v[36:37], v[154:155] op_sel_hi:[1,0]
    v_pk_mul_f32 v[38:39], v[38:39], v[154:155] op_sel_hi:[1,0]
    v_pk_mul_f32 v[40:41], v[40:41], v[154:155] op_sel_hi:[1,0]
    v_pk_mul_f32 v[42:43], v[42:43], v[154:155] op_sel_hi:[1,0]
    v_pk_mul_f32 v[44:45], v[44:45], v[154:155] op_sel_hi:[1,0]
    v_pk_mul_f32 v[46:47], v[46:47], v[154:155] op_sel_hi:[1,0]
    v_cvt_pk_bf16_f32 v228, v32, v33
    v_cvt_pk_bf16_f32 v229, v34, v35
    v_cvt_pk_bf16_f32 v230, v36, v37
    v_cvt_pk_bf16_f32 v231, v38, v39
    v_cvt_pk_bf16_f32 v232, v40, v41
    v_cvt_pk_bf16_f32 v233, v42, v43
    v_cvt_pk_bf16_f32 v234, v44, v45
    v_cvt_pk_bf16_f32 v235, v46, v47
    s_add_u32 s53, s52, 0
    buffer_store_dwordx4 v[228:231], v254, s[8:11], s53 offen sc1
    buffer_store_dwordx4 v[232:235], v254, s[8:11], s53 offen offset:1024 sc1
    ds_write_b128 v149, v[228:231] offset:0
    ds_write_b128 v149, v[232:235] offset:1024
    v_pk_fma_f32 v[48:49], v[180:181], v[152:153], v[48:49] op_sel_hi:[1,0,1]
    v_pk_fma_f32 v[50:51], v[182:183], v[152:153], v[50:51] op_sel_hi:[1,0,1]
    v_pk_fma_f32 v[52:53], v[184:185], v[152:153], v[52:53] op_sel_hi:[1,0,1]
    v_pk_fma_f32 v[54:55], v[186:187], v[152:153], v[54:55] op_sel_hi:[1,0,1]
    v_pk_fma_f32 v[56:57], v[188:189], v[152:153], v[56:57] op_sel_hi:[1,0,1]
    v_pk_fma_f32 v[58:59], v[190:191], v[152:153], v[58:59] op_sel_hi:[1,0,1]
    v_pk_fma_f32 v[60:61], v[192:193], v[152:153], v[60:61] op_sel_hi:[1,0,1]
    v_pk_fma_f32 v[62:63], v[194:195], v[152:153], v[62:63] op_sel_hi:[1,0,1]
    v_pk_mul_f32 v[48:49], v[48:49], v[156:157] op_sel_hi:[1,0]
    v_pk_mul_f32 v[50:51], v[50:51], v[156:157] op_sel_hi:[1,0]
    v_pk_mul_f32 v[52:53], v[52:53], v[156:157] op_sel_hi:[1,0]
    v_pk_mul_f32 v[54:55], v[54:55], v[156:157] op_sel_hi:[1,0]
    v_pk_mul_f32 v[56:57], v[56:57], v[156:157] op_sel_hi:[1,0]
    v_pk_mul_f32 v[58:59], v[58:59], v[156:157] op_sel_hi:[1,0]
    v_pk_mul_f32 v[60:61], v[60:61], v[156:157] op_sel_hi:[1,0]
    v_pk_mul_f32 v[62:63], v[62:63], v[156:157] op_sel_hi:[1,0]
    v_cvt_pk_bf16_f32 v236, v48, v49
    v_cvt_pk_bf16_f32 v237, v50, v51
    v_cvt_pk_bf16_f32 v238, v52, v53
    v_cvt_pk_bf16_f32 v239, v54, v55
    v_cvt_pk_bf16_f32 v240, v56, v57
    v_cvt_pk_bf16_f32 v241, v58, v59
    v_cvt_pk_bf16_f32 v242, v60, v61
    v_cvt_pk_bf16_f32 v243, v62, v63
    s_add_u32 s53, s52, 4096
    buffer_store_dwordx4 v[236:239], v254, s[8:11], s53 offen sc1
    buffer_store_dwordx4 v[240:243], v254, s[8:11], s53 offen offset:1024 sc1
    ds_write_b128 v149, v[236:239] offset:4096
    ds_write_b128 v149, v[240:243] offset:5120
    v_pk_fma_f32 v[64:65], v[196:197], v[162:163], v[64:65] op_sel_hi:[1,0,1]
    v_pk_fma_f32 v[66:67], v[198:199], v[162:163], v[66:67] op_sel_hi:[1,0,1]
    v_pk_fma_f32 v[68:69], v[200:201], v[162:163], v[68:69] op_sel_hi:[1,0,1]
    v_pk_fma_f32 v[70:71], v[202:203], v[162:163], v[70:71] op_sel_hi:[1,0,1]
    v_pk_fma_f32 v[72:73], v[204:205], v[162:163], v[72:73] op_sel_hi:[1,0,1]
    v_pk_fma_f32 v[74:75], v[206:207], v[162:163], v[74:75] op_sel_hi:[1,0,1]
    v_pk_fma_f32 v[76:77], v[208:209], v[162:163], v[76:77] op_sel_hi:[1,0,1]
    v_pk_fma_f32 v[78:79], v[210:211], v[162:163], v[78:79] op_sel_hi:[1,0,1]
    v_pk_mul_f32 v[64:65], v[64:65], v[212:213]
    v_pk_mul_f32 v[66:67], v[66:67], v[214:215]
    v_pk_mul_f32 v[68:69], v[68:69], v[216:217]
    v_pk_mul_f32 v[70:71], v[70:71], v[218:219]
    v_pk_mul_f32 v[72:73], v[72:73], v[220:221]
    v_pk_mul_f32 v[74:75], v[74:75], v[222:223]
    v_pk_mul_f32 v[76:77], v[76:77], v[224:225]
    v_pk_mul_f32 v[78:79], v[78:79], v[226:227]
    v_cvt_pk_bf16_f32 v228, v64, v65
    v_cvt_pk_bf16_f32 v229, v66, v67
    v_cvt_pk_bf16_f32 v230, v68, v69
    v_cvt_pk_bf16_f32 v231, v70, v71
    v_cvt_pk_bf16_f32 v232, v72, v73
    v_cvt_pk_bf16_f32 v233, v74, v75
    v_cvt_pk_bf16_f32 v234, v76, v77
    v_cvt_pk_bf16_f32 v235, v78, v79
    s_add_u32 s53, s52, 0
    buffer_store_dwordx4 v[228:231], v254, s[8:11], s53 offen offset:2048 sc1
    buffer_store_dwordx4 v[232:235], v254, s[8:11], s53 offen offset:3072 sc1
    ds_write_b128 v149, v[228:231] offset:2048
    ds_write_b128 v149, v[232:235] offset:3072
    v_lshrrev_b32 v144, 5, v255
    v_lshlrev_b32 v144, 4, v144
    s_lshl_b32 s39, s23, 8
    v_add_u32 v144, s39, v144
    v_add_u32 v144, 131072, v144
    ds_read_b128 v[196:199], v144 offset:128
    ds_read_b128 v[212:215], v144 offset:640
    ds_read_b128 v[200:203], v144 offset:160
    ds_read_b128 v[216:219], v144 offset:672
    ds_read_b128 v[204:207], v144 offset:192
    ds_read_b128 v[220:223], v144 offset:704
    ds_read_b128 v[208:211], v144 offset:224
    ds_read_b128 v[224:227], v144 offset:736
    s_waitcnt lgkmcnt(0)
    v_pk_fma_f32 v[80:81], v[196:197], v[162:163], v[80:81] op_sel_hi:[1,0,1]
    v_pk_fma_f32 v[82:83], v[198:199], v[162:163], v[82:83] op_sel_hi:[1,0,1]
    v_pk_fma_f32 v[84:85], v[200:201], v[162:163], v[84:85] op_sel_hi:[1,0,1]
    v_pk_fma_f32 v[86:87], v[202:203], v[162:163], v[86:87] op_sel_hi:[1,0,1]
    v_pk_fma_f32 v[88:89], v[204:205], v[162:163], v[88:89] op_sel_hi:[1,0,1]
    v_pk_fma_f32 v[90:91], v[206:207], v[162:163], v[90:91] op_sel_hi:[1,0,1]
    v_pk_fma_f32 v[92:93], v[208:209], v[162:163], v[92:93] op_sel_hi:[1,0,1]
    v_pk_fma_f32 v[94:95], v[210:211], v[162:163], v[94:95] op_sel_hi:[1,0,1]
    v_pk_mul_f32 v[80:81], v[80:81], v[212:213]
    v_pk_mul_f32 v[82:83], v[82:83], v[214:215]
    v_pk_mul_f32 v[84:85], v[84:85], v[216:217]
    v_pk_mul_f32 v[86:87], v[86:87], v[218:219]
    v_pk_mul_f32 v[88:89], v[88:89], v[220:221]
    v_pk_mul_f32 v[90:91], v[90:91], v[222:223]
    v_pk_mul_f32 v[92:93], v[92:93], v[224:225]
    v_pk_mul_f32 v[94:95], v[94:95], v[226:227]
    v_cvt_pk_bf16_f32 v236, v80, v81
    v_cvt_pk_bf16_f32 v237, v82, v83
    v_cvt_pk_bf16_f32 v238, v84, v85
    v_cvt_pk_bf16_f32 v239, v86, v87
    v_cvt_pk_bf16_f32 v240, v88, v89
    v_cvt_pk_bf16_f32 v241, v90, v91
    v_cvt_pk_bf16_f32 v242, v92, v93
    v_cvt_pk_bf16_f32 v243, v94, v95
    s_add_u32 s53, s52, 4096
    buffer_store_dwordx4 v[236:239], v254, s[8:11], s53 offen offset:2048 sc1
    buffer_store_dwordx4 v[240:243], v254, s[8:11], s53 offen offset:3072 sc1
    ds_write_b128 v149, v[236:239] offset:6144
    ds_write_b128 v149, v[240:243] offset:7168
    v_mul_f32 v158, 0x3e8293ee, v154
    v_mul_f32 v160, 0x3e8293ee, v156
    s_lshl_b32 s39, s23, 2
    s_add_u32 s39, s39, s24
    s_lshl_b32 s39, s39, 11
    s_add_u32 s39, s39, 138240
    v_add_u32 v148, s39, v254
    v_pk_fma_f32 v[0:1], v[164:165], v[150:151], v[0:1] op_sel_hi:[1,0,1]
    v_pk_fma_f32 v[2:3], v[166:167], v[150:151], v[2:3] op_sel_hi:[1,0,1]
    v_pk_fma_f32 v[4:5], v[168:169], v[150:151], v[4:5] op_sel_hi:[1,0,1]
    v_pk_fma_f32 v[6:7], v[170:171], v[150:151], v[6:7] op_sel_hi:[1,0,1]
    v_pk_fma_f32 v[8:9], v[172:173], v[150:151], v[8:9] op_sel_hi:[1,0,1]
    v_pk_fma_f32 v[10:11], v[174:175], v[150:151], v[10:11] op_sel_hi:[1,0,1]
    v_pk_fma_f32 v[12:13], v[176:177], v[150:151], v[12:13] op_sel_hi:[1,0,1]
    v_pk_fma_f32 v[14:15], v[178:179], v[150:151], v[14:15] op_sel_hi:[1,0,1]
    v_pk_mul_f32 v[0:1], v[0:1], v[158:159] op_sel_hi:[1,0]
    v_pk_mul_f32 v[2:3], v[2:3], v[158:159] op_sel_hi:[1,0]
    v_pk_mul_f32 v[4:5], v[4:5], v[158:159] op_sel_hi:[1,0]
    v_pk_mul_f32 v[6:7], v[6:7], v[158:159] op_sel_hi:[1,0]
    v_pk_mul_f32 v[8:9], v[8:9], v[158:159] op_sel_hi:[1,0]
    v_pk_mul_f32 v[10:11], v[10:11], v[158:159] op_sel_hi:[1,0]
    v_pk_mul_f32 v[12:13], v[12:13], v[158:159] op_sel_hi:[1,0]
    v_pk_mul_f32 v[14:15], v[14:15], v[158:159] op_sel_hi:[1,0]
    v_cvt_pk_bf16_f32 v196, v0, v1
    v_cvt_pk_bf16_f32 v197, v2, v3
    v_cvt_pk_bf16_f32 v198, v4, v5
    v_cvt_pk_bf16_f32 v199, v6, v7
    v_cvt_pk_bf16_f32 v200, v8, v9
    v_cvt_pk_bf16_f32 v201, v10, v11
    v_cvt_pk_bf16_f32 v202, v12, v13
    v_cvt_pk_bf16_f32 v203, v14, v15
    ds_write_b128 v148, v[196:199] offset:0
    ds_write_b128 v148, v[200:203] offset:1024
    v_pk_fma_f32 v[16:17], v[164:165], v[152:153], v[16:17] op_sel_hi:[1,0,1]
    v_pk_fma_f32 v[18:19], v[166:167], v[152:153], v[18:19] op_sel_hi:[1,0,1]
    v_pk_fma_f32 v[20:21], v[168:169], v[152:153], v[20:21] op_sel_hi:[1,0,1]
    v_pk_fma_f32 v[22:23], v[170:171], v[152:153], v[22:23] op_sel_hi:[1,0,1]
    v_pk_fma_f32 v[24:25], v[172:173], v[152:153], v[24:25] op_sel_hi:[1,0,1]
    v_pk_fma_f32 v[26:27], v[174:175], v[152:153], v[26:27] op_sel_hi:[1,0,1]
    v_pk_fma_f32 v[28:29], v[176:177], v[152:153], v[28:29] op_sel_hi:[1,0,1]
    v_pk_fma_f32 v[30:31], v[178:179], v[152:153], v[30:31] op_sel_hi:[1,0,1]
    v_pk_mul_f32 v[16:17], v[16:17], v[160:161] op_sel_hi:[1,0]
    v_pk_mul_f32 v[18:19], v[18:19], v[160:161] op_sel_hi:[1,0]
    v_pk_mul_f32 v[20:21], v[20:21], v[160:161] op_sel_hi:[1,0]
    v_pk_mul_f32 v[22:23], v[22:23], v[160:161] op_sel_hi:[1,0]
    v_pk_mul_f32 v[24:25], v[24:25], v[160:161] op_sel_hi:[1,0]
    v_pk_mul_f32 v[26:27], v[26:27], v[160:161] op_sel_hi:[1,0]
    v_pk_mul_f32 v[28:29], v[28:29], v[160:161] op_sel_hi:[1,0]
    v_pk_mul_f32 v[30:31], v[30:31], v[160:161] op_sel_hi:[1,0]
    v_cvt_pk_bf16_f32 v204, v16, v17
    v_cvt_pk_bf16_f32 v205, v18, v19
    v_cvt_pk_bf16_f32 v206, v20, v21
    v_cvt_pk_bf16_f32 v207, v22, v23
    v_cvt_pk_bf16_f32 v208, v24, v25
    v_cvt_pk_bf16_f32 v209, v26, v27
    v_cvt_pk_bf16_f32 v210, v28, v29
    v_cvt_pk_bf16_f32 v211, v30, v31
    ds_write_b128 v148, v[204:207] offset:4096
    ds_write_b128 v148, v[208:211] offset:5120
    s_waitcnt vmcnt(0) lgkmcnt(0)
    s_barrier
attention:
    s_and_b32 s50, s22, 1
    s_lshr_b32 s51, s22, 1
    s_lshl_b32 s52, s50, 16
    s_lshr_b32 s59, s22, 2
    s_lshl_b32 s39, s59, 13
    s_add_u32 s39, s39, s52
    v_add_u32 v172, s39, v254
    s_lshl_b32 s53, s21, 1
    s_add_u32 s53, s53, s50
    s_lshl_b32 s54, s53, 18
    s_add_u32 s54, s54, s63
    s_lshl_b32 s55, s51, 12
    s_add_u32 s57, s54, s55
    s_add_u32 s55, s55, s52
    s_add_u32 s58, s20, 1
    s_cmp_eq_u32 s22, 0
    s_cbranch_scc0 at_sig
    s_lshl_b32 s38, s21, 7
    s_add_u32 s38, s38, s66
    s_lshl_b32 s39, s20, 3
    v_mov_b32 v250, s39
    v_mov_b32 v248, s69
    v_not_b32 v249, v248
    s_mov_b64 exec, 1
    buffer_store_dwordx2 v[248:249], v250, s[8:11], s38 offen sc1
    s_mov_b64 exec, -1
at_sig:
    s_bitcmp1_b32 s25, 0
    s_cselect_b32 s12, s32, s30
    s_cselect_b32 s13, s33, s31
    s_and_b32 s13, s13, 0xffff
    s_mov_b32 s14, 0x200000
    s_mov_b32 s15, 0x20000
    v_lshrrev_b32 v173, 3, v255
    v_lshlrev_b32 v174, 11, v173
    v_and_b32 v173, 7, v255
    v_bfe_u32 v175, v255, 4, 1
    v_lshlrev_b32 v175, 2, v175
    v_xor_b32 v173, v173, v175
    v_lshl_add_u32 v173, v173, 4, v174
    s_bfe_u32 s49, s22, 0x10001
    s_lshl_b32 s39, s49, 2
    s_add_u32 s39, s39, s50
    s_lshl_b32 s39, s39, 11
    s_add_u32 s39, s39, 138240
    v_add_u32 v174, s39, v254
    ds_read_b128 v[0:3], v174
    ds_read_b128 v[4:7], v174 offset:1024
    ds_read_b128 v[8:11], v174 offset:4096
    ds_read_b128 v[12:15], v174 offset:5120
    v_add_u32 v175, s52, v254
    ds_read_b128 v[148:151], v175
    ds_read_b128 v[152:155], v175 offset:1024
    ds_read_b128 v[140:143], v172
    ds_read_b128 v[144:147], v172 offset:1024
    v_and_b32 v174, 3, v255
    v_bfe_u32 v175, v255, 2, 1
    v_bfe_u32 v176, v255, 4, 1
    v_xor_b32 v175, v175, v176
    v_or_b32 v174, v174, v175
    v_cmp_eq_u32 vcc, 0, v174
    v_mov_b32 v175, 0x3f803f80
    v_mov_b32 v176, 0
    v_cndmask_b32 v136, v176, v175, vcc
    v_mov_b32 v137, v136
    v_mov_b32 v138, v136
    v_mov_b32 v139, v136
    v_mov_b32 v96, 0
    v_mov_b32 v97, 0
    v_mov_b32 v98, 0
    v_mov_b32 v99, 0
    v_mov_b32 v100, 0
    v_mov_b32 v101, 0
    v_mov_b32 v102, 0
    v_mov_b32 v103, 0
    v_mov_b32 v104, 0
    v_mov_b32 v105, 0
    v_mov_b32 v106, 0
    v_mov_b32 v107, 0
    v_mov_b32 v108, 0
    v_mov_b32 v109, 0
    v_mov_b32 v110, 0
    v_mov_b32 v111, 0
    v_mov_b32 v112, 0
    v_mov_b32 v113, 0
    v_mov_b32 v114, 0
    v_mov_b32 v115, 0
    v_mov_b32 v116, 0
    v_mov_b32 v117, 0
    v_mov_b32 v118, 0
    v_mov_b32 v119, 0
    v_mov_b32 v120, 0
    v_mov_b32 v121, 0
    v_mov_b32 v122, 0
    v_mov_b32 v123, 0
    v_mov_b32 v124, 0
    v_mov_b32 v125, 0
    v_mov_b32 v126, 0
    v_mov_b32 v127, 0
    v_mov_b32 v128, 0
    v_mov_b32 v129, 0
    v_mov_b32 v130, 0
    v_mov_b32 v131, 0
    v_mov_b32 v132, 0
    v_mov_b32 v133, 0
    v_mov_b32 v134, 0
    v_mov_b32 v135, 0
    v_mov_b32 v88, 0
    v_mov_b32 v89, 0
    v_mov_b32 v90, 0
    v_mov_b32 v91, 0
    v_mov_b32 v92, 0
    v_mov_b32 v93, 0
    v_mov_b32 v94, 0
    v_mov_b32 v95, 0
    v_mov_b32 v164, 0
    v_mov_b32 v165, 0
    v_mov_b32 v166, 0
    v_mov_b32 v167, 0
    v_mov_b32 v168, 0
    v_mov_b32 v169, 0
    v_mov_b32 v170, 0
    v_mov_b32 v171, 0
    s_waitcnt lgkmcnt(0)
    v_mfma_f32_32x32x16_bf16 v[48:63], v[148:151], v[0:3], 0
    v_mfma_f32_32x32x16_bf16 v[48:63], v[152:155], v[4:7], v[48:63]
    v_mfma_f32_32x32x16_bf16 v[64:79], v[148:151], v[8:11], 0
    v_mfma_f32_32x32x16_bf16 v[64:79], v[152:155], v[12:15], v[64:79]
    s_nop 9
    v_max3_f32 v174, v48, v49, v50
    v_max3_f32 v174, v174, v51, v52
    v_max3_f32 v174, v174, v53, v54
    v_max3_f32 v174, v174, v55, v56
    v_max3_f32 v174, v174, v57, v58
    v_max3_f32 v174, v174, v59, v60
    v_max3_f32 v174, v174, v61, v62
    v_max_f32 v174, v174, v63
    v_mov_b32 v175, v174
    s_nop 1
    v_permlane32_swap_b32 v174, v175
    s_nop 1
    v_max_f32 v174, v174, v175
    v_sub_f32 v16, 0, v174
    v_mov_b32 v17, v16
    v_mov_b32 v18, v16
    v_mov_b32 v19, v16
    v_mov_b32 v20, v16
    v_mov_b32 v21, v16
    v_mov_b32 v22, v16
    v_mov_b32 v23, v16
    v_mov_b32 v24, v16
    v_mov_b32 v25, v16
    v_mov_b32 v26, v16
    v_mov_b32 v27, v16
    v_mov_b32 v28, v16
    v_mov_b32 v29, v16
    v_mov_b32 v30, v16
    v_mov_b32 v31, v16
    v_max3_f32 v176, v64, v65, v66
    v_max3_f32 v176, v176, v67, v68
    v_max3_f32 v176, v176, v69, v70
    v_max3_f32 v176, v176, v71, v72
    v_max3_f32 v176, v176, v73, v74
    v_max3_f32 v176, v176, v75, v76
    v_max3_f32 v176, v176, v77, v78
    v_max_f32 v176, v176, v79
    v_mov_b32 v177, v176
    s_nop 1
    v_permlane32_swap_b32 v176, v177
    s_nop 1
    v_max_f32 v176, v176, v177
    v_sub_f32 v32, 0, v176
    v_mov_b32 v33, v32
    v_mov_b32 v34, v32
    v_mov_b32 v35, v32
    v_mov_b32 v36, v32
    v_mov_b32 v37, v32
    v_mov_b32 v38, v32
    v_mov_b32 v39, v32
    v_mov_b32 v40, v32
    v_mov_b32 v41, v32
    v_mov_b32 v42, v32
    v_mov_b32 v43, v32
    v_mov_b32 v44, v32
    v_mov_b32 v45, v32
    v_mov_b32 v46, v32
    v_mov_b32 v47, v32
    s_nop 1
    v_mfma_f32_32x32x16_bf16 v[48:63], v[140:143], v[0:3], v[16:31]
    v_mfma_f32_32x32x16_bf16 v[48:63], v[144:147], v[4:7], v[48:63]
    s_cmp_eq_u32 s22, 0
    s_cbranch_scc0 at_pol
    s_lshl_b32 s38, s21, 7
    s_add_u32 s38, s38, s66
    v_and_b32 v250, 15, v255
    v_lshlrev_b32 v250, 3, v250
    s_mov_b32 s39, 65536
    s_not_b32 s71, s69
    buffer_load_dwordx2 v[248:249], v250, s[8:11], s38 offen sc1
poll4:
    s_waitcnt vmcnt(0)
    v_cmp_eq_u32 vcc, s69, v248
    v_cmp_eq_u32 s[72:73], s71, v249
    s_nop 0
    s_and_b64 vcc, vcc, s[72:73]
    s_cmp_eq_u64 vcc, exec
    s_cbranch_scc1 poll4_done
    buffer_load_dwordx2 v[248:249], v250, s[8:11], s38 offen sc1
    s_sub_u32 s39, s39, 1
    s_cmp_lg_u32 s39, 0
    s_cbranch_scc1 poll4
poll4_done:
at_pol:
    s_barrier
    s_and_b32 s58, s58, 15
    s_lshl_b32 s56, s58, 14
    s_add_u32 s56, s56, s57
    s_add_u32 m0, s55, 16384
    s_add_u32 s58, s58, 1
    buffer_load_dwordx4 v254, s[8:11], s56 offen offset:0 sc1 lds
    buffer_load_dwordx4 v254, s[8:11], s56 offen offset:1024 sc1 lds
    buffer_load_dwordx4 v254, s[8:11], s56 offen offset:2048 sc1 lds
    buffer_load_dwordx4 v254, s[8:11], s56 offen offset:3072 sc1 lds
    s_and_b32 s58, s58, 15
    s_lshl_b32 s56, s58, 14
    s_add_u32 s56, s56, s57
    s_add_u32 m0, s55, 32768
    s_add_u32 s58, s58, 1
    buffer_load_dwordx4 v254, s[8:11], s56 offen offset:0 sc1 lds
    buffer_load_dwordx4 v254, s[8:11], s56 offen offset:1024 sc1 lds
    buffer_load_dwordx4 v254, s[8:11], s56 offen offset:2048 sc1 lds
    buffer_load_dwordx4 v254, s[8:11], s56 offen offset:3072 sc1 lds
    s_nop 7
    s_mov_b32 s40, 3
at_loop:
    v_mfma_f32_32x32x16_bf16 v[64:79], v[140:143], v[8:11], v[32:47]
    v_exp_f32 v48, v48
    v_exp_f32 v49, v49
    v_exp_f32 v50, v50
    v_exp_f32 v51, v51
    ds_read_b128 v[148:151], v172 offset:4096
    ds_read_b128 v[152:155], v172 offset:5120
    ds_read_b128 v[156:159], v172 offset:2048
    ds_read_b128 v[160:163], v172 offset:3072
    v_mfma_f32_32x32x16_bf16 v[64:79], v[144:147], v[12:15], v[64:79]
    v_exp_f32 v52, v52
    v_exp_f32 v53, v53
    v_exp_f32 v54, v54
    v_exp_f32 v55, v55
    v_mfma_f32_32x32x16_bf16 v[112:127], v[164:167], v[88:91], v[112:127]
    v_cvt_pk_bf16_f32 v80, v48, v49
    v_cvt_pk_bf16_f32 v81, v50, v51
    v_cvt_pk_bf16_f32 v82, v52, v53
    v_cvt_pk_bf16_f32 v83, v54, v55
    v_exp_f32 v56, v56
    v_exp_f32 v57, v57
    v_mfma_f32_16x16x32_bf16 v[132:135], v[136:139], v[88:91], v[132:135]
    v_exp_f32 v58, v58
    v_exp_f32 v59, v59
    v_mfma_f32_32x32x16_bf16 v[112:127], v[168:171], v[92:95], v[112:127]
    v_exp_f32 v60, v60
    v_exp_f32 v61, v61
    v_exp_f32 v62, v62
    v_exp_f32 v63, v63
    v_mfma_f32_16x16x32_bf16 v[132:135], v[136:139], v[92:95], v[132:135]
    v_cvt_pk_bf16_f32 v84, v56, v57
    v_cvt_pk_bf16_f32 v85, v58, v59
    v_cvt_pk_bf16_f32 v86, v60, v61
    v_cvt_pk_bf16_f32 v87, v62, v63
    s_waitcnt lgkmcnt(0)
    v_mfma_f32_32x32x16_bf16 v[48:63], v[148:151], v[0:3], v[16:31]
    v_exp_f32 v64, v64
    v_exp_f32 v65, v65
    v_exp_f32 v66, v66
    v_exp_f32 v67, v67
    v_mfma_f32_32x32x16_bf16 v[48:63], v[152:155], v[4:7], v[48:63]
    v_exp_f32 v68, v68
    v_exp_f32 v69, v69
    v_exp_f32 v70, v70
    v_exp_f32 v71, v71
    v_mfma_f32_32x32x16_bf16 v[96:111], v[156:159], v[80:83], v[96:111]
    v_cvt_pk_bf16_f32 v88, v64, v65
    v_cvt_pk_bf16_f32 v89, v66, v67
    v_cvt_pk_bf16_f32 v90, v68, v69
    v_cvt_pk_bf16_f32 v91, v70, v71
    v_exp_f32 v72, v72
    v_exp_f32 v73, v73
    v_mfma_f32_16x16x32_bf16 v[128:131], v[136:139], v[80:83], v[128:131]
    v_exp_f32 v74, v74
    v_exp_f32 v75, v75
    v_mfma_f32_32x32x16_bf16 v[96:111], v[160:163], v[84:87], v[96:111]
    v_exp_f32 v76, v76
    v_exp_f32 v77, v77
    v_exp_f32 v78, v78
    v_exp_f32 v79, v79
    v_mfma_f32_16x16x32_bf16 v[128:131], v[136:139], v[84:87], v[128:131]
    v_cvt_pk_bf16_f32 v92, v72, v73
    v_cvt_pk_bf16_f32 v93, v74, v75
    v_cvt_pk_bf16_f32 v94, v76, v77
    v_cvt_pk_bf16_f32 v95, v78, v79
    s_waitcnt vmcnt(4)
    s_barrier
    s_and_b32 s58, s58, 15
    s_lshl_b32 s56, s58, 14
    s_add_u32 s56, s56, s57
    s_add_u32 m0, s55, 49152
    s_add_u32 s58, s58, 1
    buffer_load_dwordx4 v254, s[8:11], s56 offen offset:0 sc1 lds
    buffer_load_dwordx4 v254, s[8:11], s56 offen offset:1024 sc1 lds
    buffer_load_dwordx4 v254, s[8:11], s56 offen offset:2048 sc1 lds
    buffer_load_dwordx4 v254, s[8:11], s56 offen offset:3072 sc1 lds
    v_mfma_f32_32x32x16_bf16 v[64:79], v[148:151], v[8:11], v[32:47]
    v_exp_f32 v48, v48
    v_exp_f32 v49, v49
    v_exp_f32 v50, v50
    v_exp_f32 v51, v51
    ds_read_b128 v[140:143], v172 offset:16384
    ds_read_b128 v[144:147], v172 offset:17408
    ds_read_b128 v[164:167], v172 offset:6144
    ds_read_b128 v[168:171], v172 offset:7168
    v_mfma_f32_32x32x16_bf16 v[64:79], v[152:155], v[12:15], v[64:79]
    v_exp_f32 v52, v52
    v_exp_f32 v53, v53
    v_exp_f32 v54, v54
    v_exp_f32 v55, v55
    v_mfma_f32_32x32x16_bf16 v[112:127], v[156:159], v[88:91], v[112:127]
    v_cvt_pk_bf16_f32 v80, v48, v49
    v_cvt_pk_bf16_f32 v81, v50, v51
    v_cvt_pk_bf16_f32 v82, v52, v53
    v_cvt_pk_bf16_f32 v83, v54, v55
    v_exp_f32 v56, v56
    v_exp_f32 v57, v57
    v_mfma_f32_16x16x32_bf16 v[132:135], v[136:139], v[88:91], v[132:135]
    v_exp_f32 v58, v58
    v_exp_f32 v59, v59
    v_mfma_f32_32x32x16_bf16 v[112:127], v[160:163], v[92:95], v[112:127]
    v_exp_f32 v60, v60
    v_exp_f32 v61, v61
    v_exp_f32 v62, v62
    v_exp_f32 v63, v63
    v_mfma_f32_16x16x32_bf16 v[132:135], v[136:139], v[92:95], v[132:135]
    v_cvt_pk_bf16_f32 v84, v56, v57
    v_cvt_pk_bf16_f32 v85, v58, v59
    v_cvt_pk_bf16_f32 v86, v60, v61
    v_cvt_pk_bf16_f32 v87, v62, v63
    s_waitcnt lgkmcnt(0)
    v_mfma_f32_32x32x16_bf16 v[48:63], v[140:143], v[0:3], v[16:31]
    v_exp_f32 v64, v64
    v_exp_f32 v65, v65
    v_exp_f32 v66, v66
    v_exp_f32 v67, v67
    v_mfma_f32_32x32x16_bf16 v[48:63], v[144:147], v[4:7], v[48:63]
    v_exp_f32 v68, v68
    v_exp_f32 v69, v69
    v_exp_f32 v70, v70
    v_exp_f32 v71, v71
    v_mfma_f32_32x32x16_bf16 v[96:111], v[164:167], v[80:83], v[96:111]
    v_cvt_pk_bf16_f32 v88, v64, v65
    v_cvt_pk_bf16_f32 v89, v66, v67
    v_cvt_pk_bf16_f32 v90, v68, v69
    v_cvt_pk_bf16_f32 v91, v70, v71
    v_exp_f32 v72, v72
    v_exp_f32 v73, v73
    v_mfma_f32_16x16x32_bf16 v[128:131], v[136:139], v[80:83], v[128:131]
    v_exp_f32 v74, v74
    v_exp_f32 v75, v75
    v_mfma_f32_32x32x16_bf16 v[96:111], v[168:171], v[84:87], v[96:111]
    v_exp_f32 v76, v76
    v_exp_f32 v77, v77
    v_exp_f32 v78, v78
    v_exp_f32 v79, v79
    v_mfma_f32_16x16x32_bf16 v[128:131], v[136:139], v[84:87], v[128:131]
    v_cvt_pk_bf16_f32 v92, v72, v73
    v_cvt_pk_bf16_f32 v93, v74, v75
    v_cvt_pk_bf16_f32 v94, v76, v77
    v_cvt_pk_bf16_f32 v95, v78, v79
    v_mfma_f32_32x32x16_bf16 v[64:79], v[140:143], v[8:11], v[32:47]
    v_exp_f32 v48, v48
    v_exp_f32 v49, v49
    v_exp_f32 v50, v50
    v_exp_f32 v51, v51
    ds_read_b128 v[148:151], v172 offset:20480
    ds_read_b128 v[152:155], v172 offset:21504
    ds_read_b128 v[156:159], v172 offset:18432
    ds_read_b128 v[160:163], v172 offset:19456
    v_mfma_f32_32x32x16_bf16 v[64:79], v[144:147], v[12:15], v[64:79]
    v_exp_f32 v52, v52
    v_exp_f32 v53, v53
    v_exp_f32 v54, v54
    v_exp_f32 v55, v55
    v_mfma_f32_32x32x16_bf16 v[112:127], v[164:167], v[88:91], v[112:127]
    v_cvt_pk_bf16_f32 v80, v48, v49
    v_cvt_pk_bf16_f32 v81, v50, v51
    v_cvt_pk_bf16_f32 v82, v52, v53
    v_cvt_pk_bf16_f32 v83, v54, v55
    v_exp_f32 v56, v56
    v_exp_f32 v57, v57
    v_mfma_f32_16x16x32_bf16 v[132:135], v[136:139], v[88:91], v[132:135]
    v_exp_f32 v58, v58
    v_exp_f32 v59, v59
    v_mfma_f32_32x32x16_bf16 v[112:127], v[168:171], v[92:95], v[112:127]
    v_exp_f32 v60, v60
    v_exp_f32 v61, v61
    v_exp_f32 v62, v62
    v_exp_f32 v63, v63
    v_mfma_f32_16x16x32_bf16 v[132:135], v[136:139], v[92:95], v[132:135]
    v_cvt_pk_bf16_f32 v84, v56, v57
    v_cvt_pk_bf16_f32 v85, v58, v59
    v_cvt_pk_bf16_f32 v86, v60, v61
    v_cvt_pk_bf16_f32 v87, v62, v63
    s_waitcnt lgkmcnt(0)
    v_mfma_f32_32x32x16_bf16 v[48:63], v[148:151], v[0:3], v[16:31]
    v_exp_f32 v64, v64
    v_exp_f32 v65, v65
    v_exp_f32 v66, v66
    v_exp_f32 v67, v67
    v_mfma_f32_32x32x16_bf16 v[48:63], v[152:155], v[4:7], v[48:63]
    v_exp_f32 v68, v68
    v_exp_f32 v69, v69
    v_exp_f32 v70, v70
    v_exp_f32 v71, v71
    v_mfma_f32_32x32x16_bf16 v[96:111], v[156:159], v[80:83], v[96:111]
    v_cvt_pk_bf16_f32 v88, v64, v65
    v_cvt_pk_bf16_f32 v89, v66, v67
    v_cvt_pk_bf16_f32 v90, v68, v69
    v_cvt_pk_bf16_f32 v91, v70, v71
    v_exp_f32 v72, v72
    v_exp_f32 v73, v73
    v_mfma_f32_16x16x32_bf16 v[128:131], v[136:139], v[80:83], v[128:131]
    v_exp_f32 v74, v74
    v_exp_f32 v75, v75
    v_mfma_f32_32x32x16_bf16 v[96:111], v[160:163], v[84:87], v[96:111]
    v_exp_f32 v76, v76
    v_exp_f32 v77, v77
    v_exp_f32 v78, v78
    v_exp_f32 v79, v79
    v_mfma_f32_16x16x32_bf16 v[128:131], v[136:139], v[84:87], v[128:131]
    v_cvt_pk_bf16_f32 v92, v72, v73
    v_cvt_pk_bf16_f32 v93, v74, v75
    v_cvt_pk_bf16_f32 v94, v76, v77
    v_cvt_pk_bf16_f32 v95, v78, v79
    s_waitcnt vmcnt(4)
    s_barrier
    s_and_b32 s58, s58, 15
    s_lshl_b32 s56, s58, 14
    s_add_u32 s56, s56, s57
    s_add_u32 m0, s55, 0
    s_add_u32 s58, s58, 1
    buffer_load_dwordx4 v254, s[8:11], s56 offen offset:0 sc1 lds
    buffer_load_dwordx4 v254, s[8:11], s56 offen offset:1024 sc1 lds
    buffer_load_dwordx4 v254, s[8:11], s56 offen offset:2048 sc1 lds
    buffer_load_dwordx4 v254, s[8:11], s56 offen offset:3072 sc1 lds
    v_mfma_f32_32x32x16_bf16 v[64:79], v[148:151], v[8:11], v[32:47]
    v_exp_f32 v48, v48
    v_exp_f32 v49, v49
    v_exp_f32 v50, v50
    v_exp_f32 v51, v51
    ds_read_b128 v[140:143], v172 offset:32768
    ds_read_b128 v[144:147], v172 offset:33792
    ds_read_b128 v[164:167], v172 offset:22528
    ds_read_b128 v[168:171], v172 offset:23552
    v_mfma_f32_32x32x16_bf16 v[64:79], v[152:155], v[12:15], v[64:79]
    v_exp_f32 v52, v52
    v_exp_f32 v53, v53
    v_exp_f32 v54, v54
    v_exp_f32 v55, v55
    v_mfma_f32_32x32x16_bf16 v[112:127], v[156:159], v[88:91], v[112:127]
    v_cvt_pk_bf16_f32 v80, v48, v49
    v_cvt_pk_bf16_f32 v81, v50, v51
    v_cvt_pk_bf16_f32 v82, v52, v53
    v_cvt_pk_bf16_f32 v83, v54, v55
    v_exp_f32 v56, v56
    v_exp_f32 v57, v57
    v_mfma_f32_16x16x32_bf16 v[132:135], v[136:139], v[88:91], v[132:135]
    v_exp_f32 v58, v58
    v_exp_f32 v59, v59
    v_mfma_f32_32x32x16_bf16 v[112:127], v[160:163], v[92:95], v[112:127]
    v_exp_f32 v60, v60
    v_exp_f32 v61, v61
    v_exp_f32 v62, v62
    v_exp_f32 v63, v63
    v_mfma_f32_16x16x32_bf16 v[132:135], v[136:139], v[92:95], v[132:135]
    v_cvt_pk_bf16_f32 v84, v56, v57
    v_cvt_pk_bf16_f32 v85, v58, v59
    v_cvt_pk_bf16_f32 v86, v60, v61
    v_cvt_pk_bf16_f32 v87, v62, v63
    s_waitcnt lgkmcnt(0)
    v_mfma_f32_32x32x16_bf16 v[48:63], v[140:143], v[0:3], v[16:31]
    v_exp_f32 v64, v64
    v_exp_f32 v65, v65
    v_exp_f32 v66, v66
    v_exp_f32 v67, v67
    v_mfma_f32_32x32x16_bf16 v[48:63], v[144:147], v[4:7], v[48:63]
    v_exp_f32 v68, v68
    v_exp_f32 v69, v69
    v_exp_f32 v70, v70
    v_exp_f32 v71, v71
    v_mfma_f32_32x32x16_bf16 v[96:111], v[164:167], v[80:83], v[96:111]
    v_cvt_pk_bf16_f32 v88, v64, v65
    v_cvt_pk_bf16_f32 v89, v66, v67
    v_cvt_pk_bf16_f32 v90, v68, v69
    v_cvt_pk_bf16_f32 v91, v70, v71
    v_exp_f32 v72, v72
    v_exp_f32 v73, v73
    v_mfma_f32_16x16x32_bf16 v[128:131], v[136:139], v[80:83], v[128:131]
    v_exp_f32 v74, v74
    v_exp_f32 v75, v75
    v_mfma_f32_32x32x16_bf16 v[96:111], v[168:171], v[84:87], v[96:111]
    v_exp_f32 v76, v76
    v_exp_f32 v77, v77
    v_exp_f32 v78, v78
    v_exp_f32 v79, v79
    v_mfma_f32_16x16x32_bf16 v[128:131], v[136:139], v[84:87], v[128:131]
    v_cvt_pk_bf16_f32 v92, v72, v73
    v_cvt_pk_bf16_f32 v93, v74, v75
    v_cvt_pk_bf16_f32 v94, v76, v77
    v_cvt_pk_bf16_f32 v95, v78, v79
    v_mfma_f32_32x32x16_bf16 v[64:79], v[140:143], v[8:11], v[32:47]
    v_exp_f32 v48, v48
    v_exp_f32 v49, v49
    v_exp_f32 v50, v50
    v_exp_f32 v51, v51
    ds_read_b128 v[148:151], v172 offset:36864
    ds_read_b128 v[152:155], v172 offset:37888
    ds_read_b128 v[156:159], v172 offset:34816
    ds_read_b128 v[160:163], v172 offset:35840
    v_mfma_f32_32x32x16_bf16 v[64:79], v[144:147], v[12:15], v[64:79]
    v_exp_f32 v52, v52
    v_exp_f32 v53, v53
    v_exp_f32 v54, v54
    v_exp_f32 v55, v55
    v_mfma_f32_32x32x16_bf16 v[112:127], v[164:167], v[88:91], v[112:127]
    v_cvt_pk_bf16_f32 v80, v48, v49
    v_cvt_pk_bf16_f32 v81, v50, v51
    v_cvt_pk_bf16_f32 v82, v52, v53
    v_cvt_pk_bf16_f32 v83, v54, v55
    v_exp_f32 v56, v56
    v_exp_f32 v57, v57
    v_mfma_f32_16x16x32_bf16 v[132:135], v[136:139], v[88:91], v[132:135]
    v_exp_f32 v58, v58
    v_exp_f32 v59, v59
    v_mfma_f32_32x32x16_bf16 v[112:127], v[168:171], v[92:95], v[112:127]
    v_exp_f32 v60, v60
    v_exp_f32 v61, v61
    v_exp_f32 v62, v62
    v_exp_f32 v63, v63
    v_mfma_f32_16x16x32_bf16 v[132:135], v[136:139], v[92:95], v[132:135]
    v_cvt_pk_bf16_f32 v84, v56, v57
    v_cvt_pk_bf16_f32 v85, v58, v59
    v_cvt_pk_bf16_f32 v86, v60, v61
    v_cvt_pk_bf16_f32 v87, v62, v63
    s_waitcnt lgkmcnt(0)
    v_mfma_f32_32x32x16_bf16 v[48:63], v[148:151], v[0:3], v[16:31]
    v_exp_f32 v64, v64
    v_exp_f32 v65, v65
    v_exp_f32 v66, v66
    v_exp_f32 v67, v67
    v_mfma_f32_32x32x16_bf16 v[48:63], v[152:155], v[4:7], v[48:63]
    v_exp_f32 v68, v68
    v_exp_f32 v69, v69
    v_exp_f32 v70, v70
    v_exp_f32 v71, v71
    v_mfma_f32_32x32x16_bf16 v[96:111], v[156:159], v[80:83], v[96:111]
    v_cvt_pk_bf16_f32 v88, v64, v65
    v_cvt_pk_bf16_f32 v89, v66, v67
    v_cvt_pk_bf16_f32 v90, v68, v69
    v_cvt_pk_bf16_f32 v91, v70, v71
    v_exp_f32 v72, v72
    v_exp_f32 v73, v73
    v_mfma_f32_16x16x32_bf16 v[128:131], v[136:139], v[80:83], v[128:131]
    v_exp_f32 v74, v74
    v_exp_f32 v75, v75
    v_mfma_f32_32x32x16_bf16 v[96:111], v[160:163], v[84:87], v[96:111]
    v_exp_f32 v76, v76
    v_exp_f32 v77, v77
    v_exp_f32 v78, v78
    v_exp_f32 v79, v79
    v_mfma_f32_16x16x32_bf16 v[128:131], v[136:139], v[84:87], v[128:131]
    v_cvt_pk_bf16_f32 v92, v72, v73
    v_cvt_pk_bf16_f32 v93, v74, v75
    v_cvt_pk_bf16_f32 v94, v76, v77
    v_cvt_pk_bf16_f32 v95, v78, v79
    s_waitcnt vmcnt(4)
    s_barrier
    s_and_b32 s58, s58, 15
    s_lshl_b32 s56, s58, 14
    s_add_u32 s56, s56, s57
    s_add_u32 m0, s55, 16384
    s_add_u32 s58, s58, 1
    buffer_load_dwordx4 v254, s[8:11], s56 offen offset:0 sc1 lds
    buffer_load_dwordx4 v254, s[8:11], s56 offen offset:1024 sc1 lds
    buffer_load_dwordx4 v254, s[8:11], s56 offen offset:2048 sc1 lds
    buffer_load_dwordx4 v254, s[8:11], s56 offen offset:3072 sc1 lds
    v_mfma_f32_32x32x16_bf16 v[64:79], v[148:151], v[8:11], v[32:47]
    v_exp_f32 v48, v48
    v_exp_f32 v49, v49
    v_exp_f32 v50, v50
    v_exp_f32 v51, v51
    ds_read_b128 v[140:143], v172 offset:49152
    ds_read_b128 v[144:147], v172 offset:50176
    ds_read_b128 v[164:167], v172 offset:38912
    ds_read_b128 v[168:171], v172 offset:39936
    v_mfma_f32_32x32x16_bf16 v[64:79], v[152:155], v[12:15], v[64:79]
    v_exp_f32 v52, v52
    v_exp_f32 v53, v53
    v_exp_f32 v54, v54
    v_exp_f32 v55, v55
    v_mfma_f32_32x32x16_bf16 v[112:127], v[156:159], v[88:91], v[112:127]
    v_cvt_pk_bf16_f32 v80, v48, v49
    v_cvt_pk_bf16_f32 v81, v50, v51
    v_cvt_pk_bf16_f32 v82, v52, v53
    v_cvt_pk_bf16_f32 v83, v54, v55
    v_exp_f32 v56, v56
    v_exp_f32 v57, v57
    v_mfma_f32_16x16x32_bf16 v[132:135], v[136:139], v[88:91], v[132:135]
    v_exp_f32 v58, v58
    v_exp_f32 v59, v59
    v_mfma_f32_32x32x16_bf16 v[112:127], v[160:163], v[92:95], v[112:127]
    v_exp_f32 v60, v60
    v_exp_f32 v61, v61
    v_exp_f32 v62, v62
    v_exp_f32 v63, v63
    v_mfma_f32_16x16x32_bf16 v[132:135], v[136:139], v[92:95], v[132:135]
    v_cvt_pk_bf16_f32 v84, v56, v57
    v_cvt_pk_bf16_f32 v85, v58, v59
    v_cvt_pk_bf16_f32 v86, v60, v61
    v_cvt_pk_bf16_f32 v87, v62, v63
    s_waitcnt lgkmcnt(0)
    v_mfma_f32_32x32x16_bf16 v[48:63], v[140:143], v[0:3], v[16:31]
    v_exp_f32 v64, v64
    v_exp_f32 v65, v65
    v_exp_f32 v66, v66
    v_exp_f32 v67, v67
    v_mfma_f32_32x32x16_bf16 v[48:63], v[144:147], v[4:7], v[48:63]
    v_exp_f32 v68, v68
    v_exp_f32 v69, v69
    v_exp_f32 v70, v70
    v_exp_f32 v71, v71
    v_mfma_f32_32x32x16_bf16 v[96:111], v[164:167], v[80:83], v[96:111]
    v_cvt_pk_bf16_f32 v88, v64, v65
    v_cvt_pk_bf16_f32 v89, v66, v67
    v_cvt_pk_bf16_f32 v90, v68, v69
    v_cvt_pk_bf16_f32 v91, v70, v71
    v_exp_f32 v72, v72
    v_exp_f32 v73, v73
    v_mfma_f32_16x16x32_bf16 v[128:131], v[136:139], v[80:83], v[128:131]
    v_exp_f32 v74, v74
    v_exp_f32 v75, v75
    v_mfma_f32_32x32x16_bf16 v[96:111], v[168:171], v[84:87], v[96:111]
    v_exp_f32 v76, v76
    v_exp_f32 v77, v77
    v_exp_f32 v78, v78
    v_exp_f32 v79, v79
    v_mfma_f32_16x16x32_bf16 v[128:131], v[136:139], v[84:87], v[128:131]
    v_cvt_pk_bf16_f32 v92, v72, v73
    v_cvt_pk_bf16_f32 v93, v74, v75
    v_cvt_pk_bf16_f32 v94, v76, v77
    v_cvt_pk_bf16_f32 v95, v78, v79
    v_mfma_f32_32x32x16_bf16 v[64:79], v[140:143], v[8:11], v[32:47]
    v_exp_f32 v48, v48
    v_exp_f32 v49, v49
    v_exp_f32 v50, v50
    v_exp_f32 v51, v51
    ds_read_b128 v[148:151], v172 offset:53248
    ds_read_b128 v[152:155], v172 offset:54272
    ds_read_b128 v[156:159], v172 offset:51200
    ds_read_b128 v[160:163], v172 offset:52224
    v_mfma_f32_32x32x16_bf16 v[64:79], v[144:147], v[12:15], v[64:79]
    v_exp_f32 v52, v52
    v_exp_f32 v53, v53
    v_exp_f32 v54, v54
    v_exp_f32 v55, v55
    v_mfma_f32_32x32x16_bf16 v[112:127], v[164:167], v[88:91], v[112:127]
    v_cvt_pk_bf16_f32 v80, v48, v49
    v_cvt_pk_bf16_f32 v81, v50, v51
    v_cvt_pk_bf16_f32 v82, v52, v53
    v_cvt_pk_bf16_f32 v83, v54, v55
    v_exp_f32 v56, v56
    v_exp_f32 v57, v57
    v_mfma_f32_16x16x32_bf16 v[132:135], v[136:139], v[88:91], v[132:135]
    v_exp_f32 v58, v58
    v_exp_f32 v59, v59
    v_mfma_f32_32x32x16_bf16 v[112:127], v[168:171], v[92:95], v[112:127]
    v_exp_f32 v60, v60
    v_exp_f32 v61, v61
    v_exp_f32 v62, v62
    v_exp_f32 v63, v63
    v_mfma_f32_16x16x32_bf16 v[132:135], v[136:139], v[92:95], v[132:135]
    v_cvt_pk_bf16_f32 v84, v56, v57
    v_cvt_pk_bf16_f32 v85, v58, v59
    v_cvt_pk_bf16_f32 v86, v60, v61
    v_cvt_pk_bf16_f32 v87, v62, v63
    s_waitcnt lgkmcnt(0)
    v_mfma_f32_32x32x16_bf16 v[48:63], v[148:151], v[0:3], v[16:31]
    v_exp_f32 v64, v64
    v_exp_f32 v65, v65
    v_exp_f32 v66, v66
    v_exp_f32 v67, v67
    v_mfma_f32_32x32x16_bf16 v[48:63], v[152:155], v[4:7], v[48:63]
    v_exp_f32 v68, v68
    v_exp_f32 v69, v69
    v_exp_f32 v70, v70
    v_exp_f32 v71, v71
    v_mfma_f32_32x32x16_bf16 v[96:111], v[156:159], v[80:83], v[96:111]
    v_cvt_pk_bf16_f32 v88, v64, v65
    v_cvt_pk_bf16_f32 v89, v66, v67
    v_cvt_pk_bf16_f32 v90, v68, v69
    v_cvt_pk_bf16_f32 v91, v70, v71
    v_exp_f32 v72, v72
    v_exp_f32 v73, v73
    v_mfma_f32_16x16x32_bf16 v[128:131], v[136:139], v[80:83], v[128:131]
    v_exp_f32 v74, v74
    v_exp_f32 v75, v75
    v_mfma_f32_32x32x16_bf16 v[96:111], v[160:163], v[84:87], v[96:111]
    v_exp_f32 v76, v76
    v_exp_f32 v77, v77
    v_exp_f32 v78, v78
    v_exp_f32 v79, v79
    v_mfma_f32_16x16x32_bf16 v[128:131], v[136:139], v[84:87], v[128:131]
    v_cvt_pk_bf16_f32 v92, v72, v73
    v_cvt_pk_bf16_f32 v93, v74, v75
    v_cvt_pk_bf16_f32 v94, v76, v77
    v_cvt_pk_bf16_f32 v95, v78, v79
    s_waitcnt vmcnt(4)
    s_barrier
    s_and_b32 s58, s58, 15
    s_lshl_b32 s56, s58, 14
    s_add_u32 s56, s56, s57
    s_add_u32 m0, s55, 32768
    s_add_u32 s58, s58, 1
    buffer_load_dwordx4 v254, s[8:11], s56 offen offset:0 sc1 lds
    buffer_load_dwordx4 v254, s[8:11], s56 offen offset:1024 sc1 lds
    buffer_load_dwordx4 v254, s[8:11], s56 offen offset:2048 sc1 lds
    buffer_load_dwordx4 v254, s[8:11], s56 offen offset:3072 sc1 lds
    v_mfma_f32_32x32x16_bf16 v[64:79], v[148:151], v[8:11], v[32:47]
    v_exp_f32 v48, v48
    v_exp_f32 v49, v49
    v_exp_f32 v50, v50
    v_exp_f32 v51, v51
    ds_read_b128 v[140:143], v172 offset:0
    ds_read_b128 v[144:147], v172 offset:1024
    ds_read_b128 v[164:167], v172 offset:55296
    ds_read_b128 v[168:171], v172 offset:56320
    v_mfma_f32_32x32x16_bf16 v[64:79], v[152:155], v[12:15], v[64:79]
    v_exp_f32 v52, v52
    v_exp_f32 v53, v53
    v_exp_f32 v54, v54
    v_exp_f32 v55, v55
    v_mfma_f32_32x32x16_bf16 v[112:127], v[156:159], v[88:91], v[112:127]
    v_cvt_pk_bf16_f32 v80, v48, v49
    v_cvt_pk_bf16_f32 v81, v50, v51
    v_cvt_pk_bf16_f32 v82, v52, v53
    v_cvt_pk_bf16_f32 v83, v54, v55
    v_exp_f32 v56, v56
    v_exp_f32 v57, v57
    v_mfma_f32_16x16x32_bf16 v[132:135], v[136:139], v[88:91], v[132:135]
    v_exp_f32 v58, v58
    v_exp_f32 v59, v59
    v_mfma_f32_32x32x16_bf16 v[112:127], v[160:163], v[92:95], v[112:127]
    v_exp_f32 v60, v60
    v_exp_f32 v61, v61
    v_exp_f32 v62, v62
    v_exp_f32 v63, v63
    v_mfma_f32_16x16x32_bf16 v[132:135], v[136:139], v[92:95], v[132:135]
    v_cvt_pk_bf16_f32 v84, v56, v57
    v_cvt_pk_bf16_f32 v85, v58, v59
    v_cvt_pk_bf16_f32 v86, v60, v61
    v_cvt_pk_bf16_f32 v87, v62, v63
    s_waitcnt lgkmcnt(0)
    v_mfma_f32_32x32x16_bf16 v[48:63], v[140:143], v[0:3], v[16:31]
    v_exp_f32 v64, v64
    v_exp_f32 v65, v65
    v_exp_f32 v66, v66
    v_exp_f32 v67, v67
    v_mfma_f32_32x32x16_bf16 v[48:63], v[144:147], v[4:7], v[48:63]
    v_exp_f32 v68, v68
    v_exp_f32 v69, v69
    v_exp_f32 v70, v70
    v_exp_f32 v71, v71
    v_mfma_f32_32x32x16_bf16 v[96:111], v[164:167], v[80:83], v[96:111]
    v_cvt_pk_bf16_f32 v88, v64, v65
    v_cvt_pk_bf16_f32 v89, v66, v67
    v_cvt_pk_bf16_f32 v90, v68, v69
    v_cvt_pk_bf16_f32 v91, v70, v71
    v_exp_f32 v72, v72
    v_exp_f32 v73, v73
    v_mfma_f32_16x16x32_bf16 v[128:131], v[136:139], v[80:83], v[128:131]
    v_exp_f32 v74, v74
    v_exp_f32 v75, v75
    v_mfma_f32_32x32x16_bf16 v[96:111], v[168:171], v[84:87], v[96:111]
    v_exp_f32 v76, v76
    v_exp_f32 v77, v77
    v_exp_f32 v78, v78
    v_exp_f32 v79, v79
    v_mfma_f32_16x16x32_bf16 v[128:131], v[136:139], v[84:87], v[128:131]
    v_cvt_pk_bf16_f32 v92, v72, v73
    v_cvt_pk_bf16_f32 v93, v74, v75
    v_cvt_pk_bf16_f32 v94, v76, v77
    v_cvt_pk_bf16_f32 v95, v78, v79
    s_sub_u32 s40, s40, 1
    s_cmp_lg_u32 s40, 0
    s_cbranch_scc1 at_loop
    v_mfma_f32_32x32x16_bf16 v[64:79], v[140:143], v[8:11], v[32:47]
    v_exp_f32 v48, v48
    v_exp_f32 v49, v49
    v_exp_f32 v50, v50
    v_exp_f32 v51, v51
    ds_read_b128 v[148:151], v172 offset:4096
    ds_read_b128 v[152:155], v172 offset:5120
    ds_read_b128 v[156:159], v172 offset:2048
    ds_read_b128 v[160:163], v172 offset:3072
    v_mfma_f32_32x32x16_bf16 v[64:79], v[144:147], v[12:15], v[64:79]
    v_exp_f32 v52, v52
    v_exp_f32 v53, v53
    v_exp_f32 v54, v54
    v_exp_f32 v55, v55
    v_mfma_f32_32x32x16_bf16 v[112:127], v[164:167], v[88:91], v[112:127]
    v_cvt_pk_bf16_f32 v80, v48, v49
    v_cvt_pk_bf16_f32 v81, v50, v51
    v_cvt_pk_bf16_f32 v82, v52, v53
    v_cvt_pk_bf16_f32 v83, v54, v55
    v_exp_f32 v56, v56
    v_exp_f32 v57, v57
    v_mfma_f32_16x16x32_bf16 v[132:135], v[136:139], v[88:91], v[132:135]
    v_exp_f32 v58, v58
    v_exp_f32 v59, v59
    v_mfma_f32_32x32x16_bf16 v[112:127], v[168:171], v[92:95], v[112:127]
    v_exp_f32 v60, v60
    v_exp_f32 v61, v61
    v_exp_f32 v62, v62
    v_exp_f32 v63, v63
    v_mfma_f32_16x16x32_bf16 v[132:135], v[136:139], v[92:95], v[132:135]
    v_cvt_pk_bf16_f32 v84, v56, v57
    v_cvt_pk_bf16_f32 v85, v58, v59
    v_cvt_pk_bf16_f32 v86, v60, v61
    v_cvt_pk_bf16_f32 v87, v62, v63
    s_waitcnt lgkmcnt(0)
    v_mfma_f32_32x32x16_bf16 v[48:63], v[148:151], v[0:3], v[16:31]
    v_exp_f32 v64, v64
    v_exp_f32 v65, v65
    v_exp_f32 v66, v66
    v_exp_f32 v67, v67
    v_mfma_f32_32x32x16_bf16 v[48:63], v[152:155], v[4:7], v[48:63]
    v_exp_f32 v68, v68
    v_exp_f32 v69, v69
    v_exp_f32 v70, v70
    v_exp_f32 v71, v71
    v_mfma_f32_32x32x16_bf16 v[96:111], v[156:159], v[80:83], v[96:111]
    v_cvt_pk_bf16_f32 v88, v64, v65
    v_cvt_pk_bf16_f32 v89, v66, v67
    v_cvt_pk_bf16_f32 v90, v68, v69
    v_cvt_pk_bf16_f32 v91, v70, v71
    v_exp_f32 v72, v72
    v_exp_f32 v73, v73
    v_mfma_f32_16x16x32_bf16 v[128:131], v[136:139], v[80:83], v[128:131]
    v_exp_f32 v74, v74
    v_exp_f32 v75, v75
    v_mfma_f32_32x32x16_bf16 v[96:111], v[160:163], v[84:87], v[96:111]
    v_exp_f32 v76, v76
    v_exp_f32 v77, v77
    v_exp_f32 v78, v78
    v_exp_f32 v79, v79
    v_mfma_f32_16x16x32_bf16 v[128:131], v[136:139], v[84:87], v[128:131]
    v_cvt_pk_bf16_f32 v92, v72, v73
    v_cvt_pk_bf16_f32 v93, v74, v75
    v_cvt_pk_bf16_f32 v94, v76, v77
    v_cvt_pk_bf16_f32 v95, v78, v79
    s_waitcnt vmcnt(4)
    s_barrier
    s_and_b32 s58, s58, 15
    s_lshl_b32 s56, s58, 14
    s_add_u32 s56, s56, s57
    s_add_u32 m0, s55, 49152
    s_add_u32 s58, s58, 1
    buffer_load_dwordx4 v254, s[8:11], s56 offen offset:0 sc1 lds
    buffer_load_dwordx4 v254, s[8:11], s56 offen offset:1024 sc1 lds
    buffer_load_dwordx4 v254, s[8:11], s56 offen offset:2048 sc1 lds
    buffer_load_dwordx4 v254, s[8:11], s56 offen offset:3072 sc1 lds
    v_mfma_f32_32x32x16_bf16 v[64:79], v[148:151], v[8:11], v[32:47]
    v_exp_f32 v48, v48
    v_exp_f32 v49, v49
    v_exp_f32 v50, v50
    v_exp_f32 v51, v51
    ds_read_b128 v[140:143], v172 offset:16384
    ds_read_b128 v[144:147], v172 offset:17408
    ds_read_b128 v[164:167], v172 offset:6144
    ds_read_b128 v[168:171], v172 offset:7168
    v_mfma_f32_32x32x16_bf16 v[64:79], v[152:155], v[12:15], v[64:79]
    v_exp_f32 v52, v52
    v_exp_f32 v53, v53
    v_exp_f32 v54, v54
    v_exp_f32 v55, v55
    v_mfma_f32_32x32x16_bf16 v[112:127], v[156:159], v[88:91], v[112:127]
    v_cvt_pk_bf16_f32 v80, v48, v49
    v_cvt_pk_bf16_f32 v81, v50, v51
    v_cvt_pk_bf16_f32 v82, v52, v53
    v_cvt_pk_bf16_f32 v83, v54, v55
    v_exp_f32 v56, v56
    v_exp_f32 v57, v57
    v_mfma_f32_16x16x32_bf16 v[132:135], v[136:139], v[88:91], v[132:135]
    v_exp_f32 v58, v58
    v_exp_f32 v59, v59
    v_mfma_f32_32x32x16_bf16 v[112:127], v[160:163], v[92:95], v[112:127]
    v_exp_f32 v60, v60
    v_exp_f32 v61, v61
    v_exp_f32 v62, v62
    v_exp_f32 v63, v63
    v_mfma_f32_16x16x32_bf16 v[132:135], v[136:139], v[92:95], v[132:135]
    v_cvt_pk_bf16_f32 v84, v56, v57
    v_cvt_pk_bf16_f32 v85, v58, v59
    v_cvt_pk_bf16_f32 v86, v60, v61
    v_cvt_pk_bf16_f32 v87, v62, v63
    s_waitcnt lgkmcnt(0)
    v_mfma_f32_32x32x16_bf16 v[48:63], v[140:143], v[0:3], v[16:31]
    v_exp_f32 v64, v64
    v_exp_f32 v65, v65
    v_exp_f32 v66, v66
    v_exp_f32 v67, v67
    v_mfma_f32_32x32x16_bf16 v[48:63], v[144:147], v[4:7], v[48:63]
    v_exp_f32 v68, v68
    v_exp_f32 v69, v69
    v_exp_f32 v70, v70
    v_exp_f32 v71, v71
    v_mfma_f32_32x32x16_bf16 v[96:111], v[164:167], v[80:83], v[96:111]
    v_cvt_pk_bf16_f32 v88, v64, v65
    v_cvt_pk_bf16_f32 v89, v66, v67
    v_cvt_pk_bf16_f32 v90, v68, v69
    v_cvt_pk_bf16_f32 v91, v70, v71
    v_exp_f32 v72, v72
    v_exp_f32 v73, v73
    v_mfma_f32_16x16x32_bf16 v[128:131], v[136:139], v[80:83], v[128:131]
    v_exp_f32 v74, v74
    v_exp_f32 v75, v75
    v_mfma_f32_32x32x16_bf16 v[96:111], v[168:171], v[84:87], v[96:111]
    v_exp_f32 v76, v76
    v_exp_f32 v77, v77
    v_exp_f32 v78, v78
    v_exp_f32 v79, v79
    v_mfma_f32_16x16x32_bf16 v[128:131], v[136:139], v[84:87], v[128:131]
    v_cvt_pk_bf16_f32 v92, v72, v73
    v_cvt_pk_bf16_f32 v93, v74, v75
    v_cvt_pk_bf16_f32 v94, v76, v77
    v_cvt_pk_bf16_f32 v95, v78, v79
    v_mfma_f32_32x32x16_bf16 v[64:79], v[140:143], v[8:11], v[32:47]
    v_exp_f32 v48, v48
    v_exp_f32 v49, v49
    v_exp_f32 v50, v50
    v_exp_f32 v51, v51
    ds_read_b128 v[148:151], v172 offset:20480
    ds_read_b128 v[152:155], v172 offset:21504
    ds_read_b128 v[156:159], v172 offset:18432
    ds_read_b128 v[160:163], v172 offset:19456
    v_mfma_f32_32x32x16_bf16 v[64:79], v[144:147], v[12:15], v[64:79]
    v_exp_f32 v52, v52
    v_exp_f32 v53, v53
    v_exp_f32 v54, v54
    v_exp_f32 v55, v55
    v_mfma_f32_32x32x16_bf16 v[112:127], v[164:167], v[88:91], v[112:127]
    v_cvt_pk_bf16_f32 v80, v48, v49
    v_cvt_pk_bf16_f32 v81, v50, v51
    v_cvt_pk_bf16_f32 v82, v52, v53
    v_cvt_pk_bf16_f32 v83, v54, v55
    v_exp_f32 v56, v56
    v_exp_f32 v57, v57
    v_mfma_f32_16x16x32_bf16 v[132:135], v[136:139], v[88:91], v[132:135]
    v_exp_f32 v58, v58
    v_exp_f32 v59, v59
    v_mfma_f32_32x32x16_bf16 v[112:127], v[168:171], v[92:95], v[112:127]
    v_exp_f32 v60, v60
    v_exp_f32 v61, v61
    v_exp_f32 v62, v62
    v_exp_f32 v63, v63
    v_mfma_f32_16x16x32_bf16 v[132:135], v[136:139], v[92:95], v[132:135]
    v_cvt_pk_bf16_f32 v84, v56, v57
    v_cvt_pk_bf16_f32 v85, v58, v59
    v_cvt_pk_bf16_f32 v86, v60, v61
    v_cvt_pk_bf16_f32 v87, v62, v63
    s_waitcnt lgkmcnt(0)
    v_mfma_f32_32x32x16_bf16 v[48:63], v[148:151], v[0:3], v[16:31]
    v_exp_f32 v64, v64
    v_exp_f32 v65, v65
    v_exp_f32 v66, v66
    v_exp_f32 v67, v67
    v_mfma_f32_32x32x16_bf16 v[48:63], v[152:155], v[4:7], v[48:63]
    v_exp_f32 v68, v68
    v_exp_f32 v69, v69
    v_exp_f32 v70, v70
    v_exp_f32 v71, v71
    v_mfma_f32_32x32x16_bf16 v[96:111], v[156:159], v[80:83], v[96:111]
    v_cvt_pk_bf16_f32 v88, v64, v65
    v_cvt_pk_bf16_f32 v89, v66, v67
    v_cvt_pk_bf16_f32 v90, v68, v69
    v_cvt_pk_bf16_f32 v91, v70, v71
    v_exp_f32 v72, v72
    v_exp_f32 v73, v73
    v_mfma_f32_16x16x32_bf16 v[128:131], v[136:139], v[80:83], v[128:131]
    v_exp_f32 v74, v74
    v_exp_f32 v75, v75
    v_mfma_f32_32x32x16_bf16 v[96:111], v[160:163], v[84:87], v[96:111]
    v_exp_f32 v76, v76
    v_exp_f32 v77, v77
    v_exp_f32 v78, v78
    v_exp_f32 v79, v79
    v_mfma_f32_16x16x32_bf16 v[128:131], v[136:139], v[84:87], v[128:131]
    v_cvt_pk_bf16_f32 v92, v72, v73
    v_cvt_pk_bf16_f32 v93, v74, v75
    v_cvt_pk_bf16_f32 v94, v76, v77
    v_cvt_pk_bf16_f32 v95, v78, v79
    s_waitcnt vmcnt(4)
    s_barrier
    s_and_b32 s41, s22, 3
    s_lshl_b32 s41, s41, 2
    s_lshr_b32 s42, s22, 2
    s_lshl_b32 s42, s42, 6
    s_add_u32 s41, s41, s42
    s_lshl_b32 s43, s41, 14
    s_lshl_b32 s44, s21, 7
    s_add_u32 s43, s43, s44
    s_lshl_b32 s44, s41, 10
    s_mov_b32 m0, s44
    s_add_u32 s44, s44, 1024
    buffer_load_dwordx4 v173, s[12:15], s43 offen  lds
    s_add_u32 s43, s43, 16384
    s_mov_b32 m0, s44
    s_add_u32 s44, s44, 1024
    buffer_load_dwordx4 v173, s[12:15], s43 offen  lds
    s_add_u32 s43, s43, 16384
    s_mov_b32 m0, s44
    s_add_u32 s44, s44, 1024
    buffer_load_dwordx4 v173, s[12:15], s43 offen  lds
    s_add_u32 s43, s43, 16384
    s_mov_b32 m0, s44
    s_add_u32 s44, s44, 1024
    buffer_load_dwordx4 v173, s[12:15], s43 offen  lds
    v_mfma_f32_32x32x16_bf16 v[64:79], v[148:151], v[8:11], v[32:47]
    v_exp_f32 v48, v48
    v_exp_f32 v49, v49
    v_exp_f32 v50, v50
    v_exp_f32 v51, v51
    ds_read_b128 v[140:143], v172 offset:32768
    ds_read_b128 v[144:147], v172 offset:33792
    ds_read_b128 v[164:167], v172 offset:22528
    ds_read_b128 v[168:171], v172 offset:23552
    v_mfma_f32_32x32x16_bf16 v[64:79], v[152:155], v[12:15], v[64:79]
    v_exp_f32 v52, v52
    v_exp_f32 v53, v53
    v_exp_f32 v54, v54
    v_exp_f32 v55, v55
    v_mfma_f32_32x32x16_bf16 v[112:127], v[156:159], v[88:91], v[112:127]
    v_cvt_pk_bf16_f32 v80, v48, v49
    v_cvt_pk_bf16_f32 v81, v50, v51
    v_cvt_pk_bf16_f32 v82, v52, v53
    v_cvt_pk_bf16_f32 v83, v54, v55
    v_exp_f32 v56, v56
    v_exp_f32 v57, v57
    v_mfma_f32_16x16x32_bf16 v[132:135], v[136:139], v[88:91], v[132:135]
    v_exp_f32 v58, v58
    v_exp_f32 v59, v59
    v_mfma_f32_32x32x16_bf16 v[112:127], v[160:163], v[92:95], v[112:127]
    v_exp_f32 v60, v60
    v_exp_f32 v61, v61
    v_exp_f32 v62, v62
    v_exp_f32 v63, v63
    v_mfma_f32_16x16x32_bf16 v[132:135], v[136:139], v[92:95], v[132:135]
    v_cvt_pk_bf16_f32 v84, v56, v57
    v_cvt_pk_bf16_f32 v85, v58, v59
    v_cvt_pk_bf16_f32 v86, v60, v61
    v_cvt_pk_bf16_f32 v87, v62, v63
    s_waitcnt lgkmcnt(0)
    v_mfma_f32_32x32x16_bf16 v[48:63], v[140:143], v[0:3], v[16:31]
    v_exp_f32 v64, v64
    v_exp_f32 v65, v65
    v_exp_f32 v66, v66
    v_exp_f32 v67, v67
    v_mfma_f32_32x32x16_bf16 v[48:63], v[144:147], v[4:7], v[48:63]
    v_exp_f32 v68, v68
    v_exp_f32 v69, v69
    v_exp_f32 v70, v70
    v_exp_f32 v71, v71
    v_mfma_f32_32x32x16_bf16 v[96:111], v[164:167], v[80:83], v[96:111]
    v_cvt_pk_bf16_f32 v88, v64, v65
    v_cvt_pk_bf16_f32 v89, v66, v67
    v_cvt_pk_bf16_f32 v90, v68, v69
    v_cvt_pk_bf16_f32 v91, v70, v71
    v_exp_f32 v72, v72
    v_exp_f32 v73, v73
    v_mfma_f32_16x16x32_bf16 v[128:131], v[136:139], v[80:83], v[128:131]
    v_exp_f32 v74, v74
    v_exp_f32 v75, v75
    v_mfma_f32_32x32x16_bf16 v[96:111], v[168:171], v[84:87], v[96:111]
    v_exp_f32 v76, v76
    v_exp_f32 v77, v77
    v_exp_f32 v78, v78
    v_exp_f32 v79, v79
    v_mfma_f32_16x16x32_bf16 v[128:131], v[136:139], v[84:87], v[128:131]
    v_cvt_pk_bf16_f32 v92, v72, v73
    v_cvt_pk_bf16_f32 v93, v74, v75
    v_cvt_pk_bf16_f32 v94, v76, v77
    v_cvt_pk_bf16_f32 v95, v78, v79
    v_mfma_f32_32x32x16_bf16 v[64:79], v[140:143], v[8:11], v[32:47]
    v_exp_f32 v48, v48
    v_exp_f32 v49, v49
    v_exp_f32 v50, v50
    v_exp_f32 v51, v51
    ds_read_b128 v[148:151], v172 offset:36864
    ds_read_b128 v[152:155], v172 offset:37888
    ds_read_b128 v[156:159], v172 offset:34816
    ds_read_b128 v[160:163], v172 offset:35840
    v_mfma_f32_32x32x16_bf16 v[64:79], v[144:147], v[12:15], v[64:79]
    v_exp_f32 v52, v52
    v_exp_f32 v53, v53
    v_exp_f32 v54, v54
    v_exp_f32 v55, v55
    v_mfma_f32_32x32x16_bf16 v[112:127], v[164:167], v[88:91], v[112:127]
    v_cvt_pk_bf16_f32 v80, v48, v49
    v_cvt_pk_bf16_f32 v81, v50, v51
    v_cvt_pk_bf16_f32 v82, v52, v53
    v_cvt_pk_bf16_f32 v83, v54, v55
    v_exp_f32 v56, v56
    v_exp_f32 v57, v57
    v_mfma_f32_16x16x32_bf16 v[132:135], v[136:139], v[88:91], v[132:135]
    v_exp_f32 v58, v58
    v_exp_f32 v59, v59
    v_mfma_f32_32x32x16_bf16 v[112:127], v[168:171], v[92:95], v[112:127]
    v_exp_f32 v60, v60
    v_exp_f32 v61, v61
    v_exp_f32 v62, v62
    v_exp_f32 v63, v63
    v_mfma_f32_16x16x32_bf16 v[132:135], v[136:139], v[92:95], v[132:135]
    v_cvt_pk_bf16_f32 v84, v56, v57
    v_cvt_pk_bf16_f32 v85, v58, v59
    v_cvt_pk_bf16_f32 v86, v60, v61
    v_cvt_pk_bf16_f32 v87, v62, v63
    s_waitcnt lgkmcnt(0)
    v_mfma_f32_32x32x16_bf16 v[48:63], v[148:151], v[0:3], v[16:31]
    v_exp_f32 v64, v64
    v_exp_f32 v65, v65
    v_exp_f32 v66, v66
    v_exp_f32 v67, v67
    v_mfma_f32_32x32x16_bf16 v[48:63], v[152:155], v[4:7], v[48:63]
    v_exp_f32 v68, v68
    v_exp_f32 v69, v69
    v_exp_f32 v70, v70
    v_exp_f32 v71, v71
    v_mfma_f32_32x32x16_bf16 v[96:111], v[156:159], v[80:83], v[96:111]
    v_cvt_pk_bf16_f32 v88, v64, v65
    v_cvt_pk_bf16_f32 v89, v66, v67
    v_cvt_pk_bf16_f32 v90, v68, v69
    v_cvt_pk_bf16_f32 v91, v70, v71
    v_exp_f32 v72, v72
    v_exp_f32 v73, v73
    v_mfma_f32_16x16x32_bf16 v[128:131], v[136:139], v[80:83], v[128:131]
    v_exp_f32 v74, v74
    v_exp_f32 v75, v75
    v_mfma_f32_32x32x16_bf16 v[96:111], v[160:163], v[84:87], v[96:111]
    v_exp_f32 v76, v76
    v_exp_f32 v77, v77
    v_exp_f32 v78, v78
    v_exp_f32 v79, v79
    v_mfma_f32_16x16x32_bf16 v[128:131], v[136:139], v[84:87], v[128:131]
    v_cvt_pk_bf16_f32 v92, v72, v73
    v_cvt_pk_bf16_f32 v93, v74, v75
    v_cvt_pk_bf16_f32 v94, v76, v77
    v_cvt_pk_bf16_f32 v95, v78, v79
    s_waitcnt vmcnt(4)
    s_barrier
    s_and_b32 s41, s22, 3
    s_lshl_b32 s41, s41, 2
    s_lshr_b32 s42, s22, 2
    s_lshl_b32 s42, s42, 6
    s_add_u32 s41, s41, s42
    s_add_u32 s41, s41, 16
    s_lshl_b32 s43, s41, 14
    s_lshl_b32 s44, s21, 7
    s_add_u32 s43, s43, s44
    s_lshl_b32 s44, s41, 10
    s_mov_b32 m0, s44
    s_add_u32 s44, s44, 1024
    buffer_load_dwordx4 v173, s[12:15], s43 offen  lds
    s_add_u32 s43, s43, 16384
    s_mov_b32 m0, s44
    s_add_u32 s44, s44, 1024
    buffer_load_dwordx4 v173, s[12:15], s43 offen  lds
    s_add_u32 s43, s43, 16384
    s_mov_b32 m0, s44
    s_add_u32 s44, s44, 1024
    buffer_load_dwordx4 v173, s[12:15], s43 offen  lds
    s_add_u32 s43, s43, 16384
    s_mov_b32 m0, s44
    s_add_u32 s44, s44, 1024
    buffer_load_dwordx4 v173, s[12:15], s43 offen  lds
    v_mfma_f32_32x32x16_bf16 v[64:79], v[148:151], v[8:11], v[32:47]
    v_exp_f32 v48, v48
    v_exp_f32 v49, v49
    v_exp_f32 v50, v50
    v_exp_f32 v51, v51
    ds_read_b128 v[140:143], v172 offset:49152
    ds_read_b128 v[144:147], v172 offset:50176
    ds_read_b128 v[164:167], v172 offset:38912
    ds_read_b128 v[168:171], v172 offset:39936
    v_mfma_f32_32x32x16_bf16 v[64:79], v[152:155], v[12:15], v[64:79]
    v_exp_f32 v52, v52
    v_exp_f32 v53, v53
    v_exp_f32 v54, v54
    v_exp_f32 v55, v55
    v_mfma_f32_32x32x16_bf16 v[112:127], v[156:159], v[88:91], v[112:127]
    v_cvt_pk_bf16_f32 v80, v48, v49
    v_cvt_pk_bf16_f32 v81, v50, v51
    v_cvt_pk_bf16_f32 v82, v52, v53
    v_cvt_pk_bf16_f32 v83, v54, v55
    v_exp_f32 v56, v56
    v_exp_f32 v57, v57
    v_mfma_f32_16x16x32_bf16 v[132:135], v[136:139], v[88:91], v[132:135]
    v_exp_f32 v58, v58
    v_exp_f32 v59, v59
    v_mfma_f32_32x32x16_bf16 v[112:127], v[160:163], v[92:95], v[112:127]
    v_exp_f32 v60, v60
    v_exp_f32 v61, v61
    v_exp_f32 v62, v62
    v_exp_f32 v63, v63
    v_mfma_f32_16x16x32_bf16 v[132:135], v[136:139], v[92:95], v[132:135]
    v_cvt_pk_bf16_f32 v84, v56, v57
    v_cvt_pk_bf16_f32 v85, v58, v59
    v_cvt_pk_bf16_f32 v86, v60, v61
    v_cvt_pk_bf16_f32 v87, v62, v63
    s_waitcnt lgkmcnt(0)
    v_mfma_f32_32x32x16_bf16 v[48:63], v[140:143], v[0:3], v[16:31]
    v_exp_f32 v64, v64
    v_exp_f32 v65, v65
    v_exp_f32 v66, v66
    v_exp_f32 v67, v67
    v_mfma_f32_32x32x16_bf16 v[48:63], v[144:147], v[4:7], v[48:63]
    v_exp_f32 v68, v68
    v_exp_f32 v69, v69
    v_exp_f32 v70, v70
    v_exp_f32 v71, v71
    v_mfma_f32_32x32x16_bf16 v[96:111], v[164:167], v[80:83], v[96:111]
    v_cvt_pk_bf16_f32 v88, v64, v65
    v_cvt_pk_bf16_f32 v89, v66, v67
    v_cvt_pk_bf16_f32 v90, v68, v69
    v_cvt_pk_bf16_f32 v91, v70, v71
    v_exp_f32 v72, v72
    v_exp_f32 v73, v73
    v_mfma_f32_16x16x32_bf16 v[128:131], v[136:139], v[80:83], v[128:131]
    v_exp_f32 v74, v74
    v_exp_f32 v75, v75
    v_mfma_f32_32x32x16_bf16 v[96:111], v[168:171], v[84:87], v[96:111]
    v_exp_f32 v76, v76
    v_exp_f32 v77, v77
    v_exp_f32 v78, v78
    v_exp_f32 v79, v79
    v_mfma_f32_16x16x32_bf16 v[128:131], v[136:139], v[84:87], v[128:131]
    v_cvt_pk_bf16_f32 v92, v72, v73
    v_cvt_pk_bf16_f32 v93, v74, v75
    v_cvt_pk_bf16_f32 v94, v76, v77
    v_cvt_pk_bf16_f32 v95, v78, v79
    v_mfma_f32_32x32x16_bf16 v[64:79], v[140:143], v[8:11], v[32:47]
    v_exp_f32 v48, v48
    v_exp_f32 v49, v49
    v_exp_f32 v50, v50
    v_exp_f32 v51, v51
    ds_read_b128 v[148:151], v172 offset:53248
    ds_read_b128 v[152:155], v172 offset:54272
    ds_read_b128 v[156:159], v172 offset:51200
    ds_read_b128 v[160:163], v172 offset:52224
    v_mfma_f32_32x32x16_bf16 v[64:79], v[144:147], v[12:15], v[64:79]
    v_exp_f32 v52, v52
    v_exp_f32 v53, v53
    v_exp_f32 v54, v54
    v_exp_f32 v55, v55
    v_mfma_f32_32x32x16_bf16 v[112:127], v[164:167], v[88:91], v[112:127]
    v_cvt_pk_bf16_f32 v80, v48, v49
    v_cvt_pk_bf16_f32 v81, v50, v51
    v_cvt_pk_bf16_f32 v82, v52, v53
    v_cvt_pk_bf16_f32 v83, v54, v55
    v_exp_f32 v56, v56
    v_exp_f32 v57, v57
    v_mfma_f32_16x16x32_bf16 v[132:135], v[136:139], v[88:91], v[132:135]
    v_exp_f32 v58, v58
    v_exp_f32 v59, v59
    v_mfma_f32_32x32x16_bf16 v[112:127], v[168:171], v[92:95], v[112:127]
    v_exp_f32 v60, v60
    v_exp_f32 v61, v61
    v_exp_f32 v62, v62
    v_exp_f32 v63, v63
    v_mfma_f32_16x16x32_bf16 v[132:135], v[136:139], v[92:95], v[132:135]
    v_cvt_pk_bf16_f32 v84, v56, v57
    v_cvt_pk_bf16_f32 v85, v58, v59
    v_cvt_pk_bf16_f32 v86, v60, v61
    v_cvt_pk_bf16_f32 v87, v62, v63
    s_waitcnt lgkmcnt(0)
    v_mfma_f32_32x32x16_bf16 v[48:63], v[148:151], v[0:3], v[16:31]
    v_exp_f32 v64, v64
    v_exp_f32 v65, v65
    v_exp_f32 v66, v66
    v_exp_f32 v67, v67
    v_mfma_f32_32x32x16_bf16 v[48:63], v[152:155], v[4:7], v[48:63]
    v_exp_f32 v68, v68
    v_exp_f32 v69, v69
    v_exp_f32 v70, v70
    v_exp_f32 v71, v71
    v_mfma_f32_32x32x16_bf16 v[96:111], v[156:159], v[80:83], v[96:111]
    v_cvt_pk_bf16_f32 v88, v64, v65
    v_cvt_pk_bf16_f32 v89, v66, v67
    v_cvt_pk_bf16_f32 v90, v68, v69
    v_cvt_pk_bf16_f32 v91, v70, v71
    v_exp_f32 v72, v72
    v_exp_f32 v73, v73
    v_mfma_f32_16x16x32_bf16 v[128:131], v[136:139], v[80:83], v[128:131]
    v_exp_f32 v74, v74
    v_exp_f32 v75, v75
    v_mfma_f32_32x32x16_bf16 v[96:111], v[160:163], v[84:87], v[96:111]
    v_exp_f32 v76, v76
    v_exp_f32 v77, v77
    v_exp_f32 v78, v78
    v_exp_f32 v79, v79
    v_mfma_f32_16x16x32_bf16 v[128:131], v[136:139], v[84:87], v[128:131]
    v_cvt_pk_bf16_f32 v92, v72, v73
    v_cvt_pk_bf16_f32 v93, v74, v75
    v_cvt_pk_bf16_f32 v94, v76, v77
    v_cvt_pk_bf16_f32 v95, v78, v79
    v_mfma_f32_32x32x16_bf16 v[64:79], v[148:151], v[8:11], v[32:47]
    v_exp_f32 v48, v48
    v_exp_f32 v49, v49
    v_exp_f32 v50, v50
    v_exp_f32 v51, v51
    ds_read_b128 v[164:167], v172 offset:55296
    ds_read_b128 v[168:171], v172 offset:56320
    v_mfma_f32_32x32x16_bf16 v[64:79], v[152:155], v[12:15], v[64:79]
    v_exp_f32 v52, v52
    v_exp_f32 v53, v53
    v_exp_f32 v54, v54
    v_exp_f32 v55, v55
    v_mfma_f32_32x32x16_bf16 v[112:127], v[156:159], v[88:91], v[112:127]
    v_cvt_pk_bf16_f32 v80, v48, v49
    v_cvt_pk_bf16_f32 v81, v50, v51
    v_cvt_pk_bf16_f32 v82, v52, v53
    v_cvt_pk_bf16_f32 v83, v54, v55
    v_exp_f32 v56, v56
    v_exp_f32 v57, v57
    v_mfma_f32_16x16x32_bf16 v[132:135], v[136:139], v[88:91], v[132:135]
    v_exp_f32 v58, v58
    v_exp_f32 v59, v59
    v_mfma_f32_32x32x16_bf16 v[112:127], v[160:163], v[92:95], v[112:127]
    v_exp_f32 v60, v60
    v_exp_f32 v61, v61
    v_exp_f32 v62, v62
    v_exp_f32 v63, v63
    v_mfma_f32_16x16x32_bf16 v[132:135], v[136:139], v[92:95], v[132:135]
    v_cvt_pk_bf16_f32 v84, v56, v57
    v_cvt_pk_bf16_f32 v85, v58, v59
    v_cvt_pk_bf16_f32 v86, v60, v61
    v_cvt_pk_bf16_f32 v87, v62, v63
    s_waitcnt lgkmcnt(0)
    v_exp_f32 v64, v64
    v_exp_f32 v65, v65
    v_exp_f32 v66, v66
    v_exp_f32 v67, v67
    v_exp_f32 v68, v68
    v_exp_f32 v69, v69
    v_exp_f32 v70, v70
    v_exp_f32 v71, v71
    v_mfma_f32_32x32x16_bf16 v[96:111], v[164:167], v[80:83], v[96:111]
    v_cvt_pk_bf16_f32 v88, v64, v65
    v_cvt_pk_bf16_f32 v89, v66, v67
    v_cvt_pk_bf16_f32 v90, v68, v69
    v_cvt_pk_bf16_f32 v91, v70, v71
    v_exp_f32 v72, v72
    v_exp_f32 v73, v73
    v_mfma_f32_16x16x32_bf16 v[128:131], v[136:139], v[80:83], v[128:131]
    v_exp_f32 v74, v74
    v_exp_f32 v75, v75
    v_mfma_f32_32x32x16_bf16 v[96:111], v[168:171], v[84:87], v[96:111]
    v_exp_f32 v76, v76
    v_exp_f32 v77, v77
    v_exp_f32 v78, v78
    v_exp_f32 v79, v79
    v_mfma_f32_16x16x32_bf16 v[128:131], v[136:139], v[84:87], v[128:131]
    v_cvt_pk_bf16_f32 v92, v72, v73
    v_cvt_pk_bf16_f32 v93, v74, v75
    v_cvt_pk_bf16_f32 v94, v76, v77
    v_cvt_pk_bf16_f32 v95, v78, v79
    s_nop 1
    v_mfma_f32_32x32x16_bf16 v[112:127], v[164:167], v[88:91], v[112:127]
    v_mfma_f32_16x16x32_bf16 v[132:135], v[136:139], v[88:91], v[132:135]
    v_mfma_f32_32x32x16_bf16 v[112:127], v[168:171], v[92:95], v[112:127]
    v_mfma_f32_16x16x32_bf16 v[132:135], v[136:139], v[92:95], v[132:135]
    s_barrier
    s_lshl_b32 s39, s49, 1
    s_add_u32 s41, s39, s59
    s_xor_b32 s42, s41, 1
    s_mul_i32 s42, s42, 4608
    s_mul_i32 s43, s41, 4608
    s_add_u32 s44, s52, 32768
    s_add_u32 s42, s42, s44
    s_add_u32 s43, s43, s44
    v_add_u32 v174, s42, v254
    v_add_u32 v175, s43, v254
    v_lshlrev_b32 v176, 2, v255
    v_add_u32 v177, s43, v176
    v_add_u32 v176, s42, v176
    s_nop 4
    s_cmp_eq_u32 s59, 0
    s_cbranch_scc0 at_k1
    ds_write_b128 v174, v[112:115] offset:0
    ds_write_b128 v174, v[116:119] offset:1024
    ds_write_b128 v174, v[120:123] offset:2048
    ds_write_b128 v174, v[124:127] offset:3072
    ds_write_b32 v176, v132 offset:4096
    s_branch at_k2
at_k1:
    ds_write_b128 v174, v[96:99] offset:0
    ds_write_b128 v174, v[100:103] offset:1024
    ds_write_b128 v174, v[104:107] offset:2048
    ds_write_b128 v174, v[108:111] offset:3072
    ds_write_b32 v176, v128 offset:4096
    v_mov_b32 v96, v112
    v_mov_b32 v97, v113
    v_mov_b32 v98, v114
    v_mov_b32 v99, v115
    v_mov_b32 v100, v116
    v_mov_b32 v101, v117
    v_mov_b32 v102, v118
    v_mov_b32 v103, v119
    v_mov_b32 v104, v120
    v_mov_b32 v105, v121
    v_mov_b32 v106, v122
    v_mov_b32 v107, v123
    v_mov_b32 v108, v124
    v_mov_b32 v109, v125
    v_mov_b32 v110, v126
    v_mov_b32 v111, v127
    v_mov_b32 v128, v132
    v_mov_b32 v0, v8
    v_mov_b32 v1, v9
    v_mov_b32 v2, v10
    v_mov_b32 v3, v11
    v_mov_b32 v4, v12
    v_mov_b32 v5, v13
    v_mov_b32 v6, v14
    v_mov_b32 v7, v15
at_k2:
    s_waitcnt lgkmcnt(0)
    s_barrier
    ds_read_b128 v[48:51], v175 offset:0
    ds_read_b128 v[52:55], v175 offset:1024
    ds_read_b128 v[56:59], v175 offset:2048
    ds_read_b128 v[60:63], v175 offset:3072
    ds_read_b32 v64, v177 offset:4096
    s_waitcnt lgkmcnt(0)
    v_pk_add_f32 v[96:97], v[96:97], v[48:49]
    v_pk_add_f32 v[98:99], v[98:99], v[50:51]
    v_pk_add_f32 v[100:101], v[100:101], v[52:53]
    v_pk_add_f32 v[102:103], v[102:103], v[54:55]
    v_pk_add_f32 v[104:105], v[104:105], v[56:57]
    v_pk_add_f32 v[106:107], v[106:107], v[58:59]
    v_pk_add_f32 v[108:109], v[108:109], v[60:61]
    v_pk_add_f32 v[110:111], v[110:111], v[62:63]
    v_add_f32 v128, v128, v64
    v_mov_b32 v174, 0
    v_fma_f32 v174, v96, 0, v174
    v_fma_f32 v174, v97, 0, v174
    v_fma_f32 v174, v98, 0, v174
    v_fma_f32 v174, v99, 0, v174
    v_fma_f32 v174, v100, 0, v174
    v_fma_f32 v174, v101, 0, v174
    v_fma_f32 v174, v102, 0, v174
    v_fma_f32 v174, v103, 0, v174
    v_fma_f32 v174, v104, 0, v174
    v_fma_f32 v174, v105, 0, v174
    v_fma_f32 v174, v106, 0, v174
    v_fma_f32 v174, v107, 0, v174
    v_fma_f32 v174, v108, 0, v174
    v_fma_f32 v174, v109, 0, v174
    v_fma_f32 v174, v110, 0, v174
    v_fma_f32 v174, v111, 0, v174
    v_cmp_eq_f32 vcc, 0, v174
    v_mov_b32 v175, 0x71800000
    v_cmp_lt_f32 s[42:43], v128, v175
    s_nop 1
    s_and_b64 vcc, vcc, s[42:43]
    s_cmp_eq_u64 vcc, exec
    s_cbranch_scc1 at_fin
    v_mov_b32 v96, 0
    v_mov_b32 v97, 0
    v_mov_b32 v98, 0
    v_mov_b32 v99, 0
    v_mov_b32 v100, 0
    v_mov_b32 v101, 0
    v_mov_b32 v102, 0
    v_mov_b32 v103, 0
    v_mov_b32 v104, 0
    v_mov_b32 v105, 0
    v_mov_b32 v106, 0
    v_mov_b32 v107, 0
    v_mov_b32 v108, 0
    v_mov_b32 v109, 0
    v_mov_b32 v110, 0
    v_mov_b32 v111, 0
    v_mov_b32 v128, 0
    v_mov_b32 v129, 0
    v_mov_b32 v130, 0
    v_mov_b32 v131, 0
    v_mov_b32 v176, 0xff61b1e6
    s_mov_b32 s45, s54
    s_mov_b32 s40, 64
at_fb:
    buffer_load_dwordx4 v[140:143], v254, s[8:11], s45 offen offset:0 sc1
    buffer_load_dwordx4 v[144:147], v254, s[8:11], s45 offen offset:1024 sc1
    buffer_load_dwordx4 v[148:151], v254, s[8:11], s45 offen offset:2048 sc1
    buffer_load_dwordx4 v[152:155], v254, s[8:11], s45 offen offset:3072 sc1
    s_waitcnt vmcnt(0)
    v_mfma_f32_32x32x16_bf16 v[48:63], v[140:143], v[0:3], 0
    v_mfma_f32_32x32x16_bf16 v[48:63], v[144:147], v[4:7], v[48:63]
    s_nop 15
    v_max3_f32 v174, v48, v49, v50
    v_max3_f32 v174, v174, v51, v52
    v_max3_f32 v174, v174, v53, v54
    v_max3_f32 v174, v174, v55, v56
    v_max3_f32 v174, v174, v57, v58
    v_max3_f32 v174, v174, v59, v60
    v_max3_f32 v174, v174, v61, v62
    v_max_f32 v174, v174, v63
    v_mov_b32 v175, v174
    s_nop 1
    v_permlane32_swap_b32 v174, v175
    s_nop 1
    v_max3_f32 v174, v174, v175, v176
    v_sub_f32 v175, v176, v174
    v_exp_f32 v175, v175
    v_mov_b32 v176, v174
    v_sub_f32 v48, v48, v174
    v_sub_f32 v49, v49, v174
    v_sub_f32 v50, v50, v174
    v_sub_f32 v51, v51, v174
    v_sub_f32 v52, v52, v174
    v_sub_f32 v53, v53, v174
    v_sub_f32 v54, v54, v174
    v_sub_f32 v55, v55, v174
    v_sub_f32 v56, v56, v174
    v_sub_f32 v57, v57, v174
    v_sub_f32 v58, v58, v174
    v_sub_f32 v59, v59, v174
    v_sub_f32 v60, v60, v174
    v_sub_f32 v61, v61, v174
    v_sub_f32 v62, v62, v174
    v_sub_f32 v63, v63, v174
    v_exp_f32 v48, v48
    v_exp_f32 v49, v49
    v_exp_f32 v50, v50
    v_exp_f32 v51, v51
    v_exp_f32 v52, v52
    v_exp_f32 v53, v53
    v_exp_f32 v54, v54
    v_exp_f32 v55, v55
    v_exp_f32 v56, v56
    v_exp_f32 v57, v57
    v_exp_f32 v58, v58
    v_exp_f32 v59, v59
    v_exp_f32 v60, v60
    v_exp_f32 v61, v61
    v_exp_f32 v62, v62
    v_exp_f32 v63, v63
    v_mul_f32 v96, v96, v175
    v_mul_f32 v97, v97, v175
    v_mul_f32 v98, v98, v175
    v_mul_f32 v99, v99, v175
    v_mul_f32 v100, v100, v175
    v_mul_f32 v101, v101, v175
    v_mul_f32 v102, v102, v175
    v_mul_f32 v103, v103, v175
    v_mul_f32 v104, v104, v175
    v_mul_f32 v105, v105, v175
    v_mul_f32 v106, v106, v175
    v_mul_f32 v107, v107, v175
    v_mul_f32 v108, v108, v175
    v_mul_f32 v109, v109, v175
    v_mul_f32 v110, v110, v175
    v_mul_f32 v111, v111, v175
    v_mul_f32 v128, v128, v175
    v_mul_f32 v129, v129, v175
    v_mul_f32 v130, v130, v175
    v_mul_f32 v131, v131, v175
    v_cvt_pk_bf16_f32 v80, v48, v49
    v_cvt_pk_bf16_f32 v81, v50, v51
    v_cvt_pk_bf16_f32 v82, v52, v53
    v_cvt_pk_bf16_f32 v83, v54, v55
    v_cvt_pk_bf16_f32 v84, v56, v57
    v_cvt_pk_bf16_f32 v85, v58, v59
    v_cvt_pk_bf16_f32 v86, v60, v61
    v_cvt_pk_bf16_f32 v87, v62, v63
    s_nop 1
    v_mfma_f32_32x32x16_bf16 v[96:111], v[148:151], v[80:83], v[96:111]
    v_mfma_f32_16x16x32_bf16 v[128:131], v[136:139], v[80:83], v[128:131]
    v_mfma_f32_32x32x16_bf16 v[96:111], v[152:155], v[84:87], v[96:111]
    v_mfma_f32_16x16x32_bf16 v[128:131], v[136:139], v[84:87], v[128:131]
    s_nop 15
    s_add_u32 s45, s45, 4096
    s_sub_u32 s40, s40, 1
    s_cmp_lg_u32 s40, 0
    s_cbranch_scc1 at_fb
at_fin:
    v_rcp_f32 v174, v128
    s_nop 0
    v_mul_f32 v96, v96, v174
    v_mul_f32 v97, v97, v174
    v_mul_f32 v98, v98, v174
    v_mul_f32 v99, v99, v174
    v_mul_f32 v100, v100, v174
    v_mul_f32 v101, v101, v174
    v_mul_f32 v102, v102, v174
    v_mul_f32 v103, v103, v174
    v_mul_f32 v104, v104, v174
    v_mul_f32 v105, v105, v174
    v_mul_f32 v106, v106, v174
    v_mul_f32 v107, v107, v174
    v_mul_f32 v108, v108, v174
    v_mul_f32 v109, v109, v174
    v_mul_f32 v110, v110, v174
    v_mul_f32 v111, v111, v174
    v_cvt_pk_bf16_f32 v80, v96, v97
    v_cvt_pk_bf16_f32 v81, v98, v99
    v_cvt_pk_bf16_f32 v82, v100, v101
    v_cvt_pk_bf16_f32 v83, v102, v103
    v_cvt_pk_bf16_f32 v84, v104, v105
    v_cvt_pk_bf16_f32 v85, v106, v107
    v_cvt_pk_bf16_f32 v86, v108, v109
    v_cvt_pk_bf16_f32 v87, v110, v111
    s_lshl_b32 s39, s20, 2
    s_add_u32 s39, s39, s41
    s_lshl_b32 s39, s39, 16
    s_lshl_b32 s40, s53, 11
    s_add_u32 s39, s39, s40
    s_add_u32 s39, s39, s62
    buffer_store_dwordx4 v[80:83], v254, s[8:11], s39 offen sc1
    buffer_store_dwordx4 v[84:87], v254, s[8:11], s39 offen offset:1024 sc1
    s_waitcnt vmcnt(0)
    s_cmp_lt_u32 s22, 4
    s_cbranch_scc1 m_f1
    s_barrier
    s_sub_u32 s41, s22, 4
    s_lshl_b32 s41, s41, 3
    s_add_u32 s41, s41, 32
    s_lshl_b32 s43, s41, 14
    s_lshl_b32 s44, s21, 7
    s_add_u32 s43, s43, s44
    s_lshl_b32 s44, s41, 10
    s_mov_b32 m0, s44
    s_add_u32 s44, s44, 1024
    buffer_load_dwordx4 v173, s[12:15], s43 offen  lds
    s_add_u32 s43, s43, 16384
    s_mov_b32 m0, s44
    s_add_u32 s44, s44, 1024
    buffer_load_dwordx4 v173, s[12:15], s43 offen  lds
    s_add_u32 s43, s43, 16384
    s_mov_b32 m0, s44
    s_add_u32 s44, s44, 1024
    buffer_load_dwordx4 v173, s[12:15], s43 offen  lds
    s_add_u32 s43, s43, 16384
    s_mov_b32 m0, s44
    s_add_u32 s44, s44, 1024
    buffer_load_dwordx4 v173, s[12:15], s43 offen  lds
    s_add_u32 s43, s43, 16384
    s_mov_b32 m0, s44
    s_add_u32 s44, s44, 1024
    buffer_load_dwordx4 v173, s[12:15], s43 offen  lds
    s_add_u32 s43, s43, 16384
    s_mov_b32 m0, s44
    s_add_u32 s44, s44, 1024
    buffer_load_dwordx4 v173, s[12:15], s43 offen  lds
    s_add_u32 s43, s43, 16384
    s_mov_b32 m0, s44
    s_add_u32 s44, s44, 1024
    buffer_load_dwordx4 v173, s[12:15], s43 offen  lds
    s_add_u32 s43, s43, 16384
    s_mov_b32 m0, s44
    s_add_u32 s44, s44, 1024
    buffer_load_dwordx4 v173, s[12:15], s43 offen  lds
    s_add_u32 s41, s41, 64
    s_lshl_b32 s43, s41, 14
    s_lshl_b32 s44, s21, 7
    s_add_u32 s43, s43, s44
    s_lshl_b32 s44, s41, 10
    s_mov_b32 m0, s44
    s_add_u32 s44, s44, 1024
    buffer_load_dwordx4 v173, s[12:15], s43 offen  lds
    s_add_u32 s43, s43, 16384
    s_mov_b32 m0, s44
    s_add_u32 s44, s44, 1024
    buffer_load_dwordx4 v173, s[12:15], s43 offen  lds
    s_add_u32 s43, s43, 16384
    s_mov_b32 m0, s44
    s_add_u32 s44, s44, 1024
    buffer_load_dwordx4 v173, s[12:15], s43 offen  lds
    s_add_u32 s43, s43, 16384
    s_mov_b32 m0, s44
    s_add_u32 s44, s44, 1024
    buffer_load_dwordx4 v173, s[12:15], s43 offen  lds
    s_add_u32 s43, s43, 16384
    s_mov_b32 m0, s44
    s_add_u32 s44, s44, 1024
    buffer_load_dwordx4 v173, s[12:15], s43 offen  lds
    s_add_u32 s43, s43, 16384
    s_mov_b32 m0, s44
    s_add_u32 s44, s44, 1024
    buffer_load_dwordx4 v173, s[12:15], s43 offen  lds
    s_add_u32 s43, s43, 16384
    s_mov_b32 m0, s44
    s_add_u32 s44, s44, 1024
    buffer_load_dwordx4 v173, s[12:15], s43 offen  lds
    s_add_u32 s43, s43, 16384
    s_mov_b32 m0, s44
    s_add_u32 s44, s44, 1024
    buffer_load_dwordx4 v173, s[12:15], s43 offen  lds
    s_barrier
l_p3:
    s_waitcnt vmcnt(0)
l_f3:
    s_barrier
    s_add_u32 s25, s25, 1
    s_cmp_lt_u32 s25, 4
    s_cbranch_scc1 l_layer
    s_endpgm
m_f1:
    s_barrier
    s_cmp_eq_u32 s22, 0
    s_cbranch_scc0 m_ho_s
    s_lshl_b32 s38, s20, 7
    s_add_u32 s38, s38, s66
    s_add_u32 s38, s38, 2048
    s_lshl_b32 s39, s21, 3
    v_mov_b32 v250, s39
    v_mov_b32 v248, s69
    v_not_b32 v249, v248
    s_mov_b64 exec, 1
    buffer_store_dwordx2 v[248:249], v250, s[8:11], s38 offen sc1
    s_mov_b64 exec, -1
m_ho_s:
    s_lshl_b32 s50, s20, 2
    s_add_u32 s50, s50, s22
    s_lshl_b32 s51, s50, 16
    s_lshl_b32 s39, s21, 12
    s_add_u32 s52, s51, s39
    s_add_u32 s53, s52, s60
    buffer_load_dwordx4 v[112:115], v254, s[8:11], s53 offen offset:0 sc1
    buffer_load_dwordx4 v[116:119], v254, s[8:11], s53 offen offset:1024 sc1
    buffer_load_dwordx4 v[120:123], v254, s[8:11], s53 offen offset:2048 sc1
    buffer_load_dwordx4 v[124:127], v254, s[8:11], s53 offen offset:3072 sc1
    s_add_u32 s54, s51, s62
    v_lshrrev_b32 v132, 5, v255
    v_bfe_u32 v133, v255, 2, 2
    v_lshl_add_u32 v132, v132, 2, v133
    v_lshlrev_b32 v132, 7, v132
    v_bfe_u32 v133, v255, 4, 1
    v_bfe_u32 v134, v255, 1, 1
    v_lshl_add_u32 v133, v133, 1, v134
    v_bfe_u32 v134, v255, 3, 1
    v_lshlrev_b32 v134, 2, v134
    v_xor_b32 v133, v133, v134
    v_lshl_add_u32 v132, v133, 4, v132
    v_and_b32 v133, 1, v255
    v_lshl_add_u32 v128, v133, 3, v132
    v_xor_b32 v129, 64, v128
    v_add_u32 v130, 0x10000, v128
    v_add_u32 v131, 0x10000, v129
    v_mov_b32 v0, 0
    v_mov_b32 v1, 0
    v_mov_b32 v2, 0
    v_mov_b32 v3, 0
    v_mov_b32 v4, 0
    v_mov_b32 v5, 0
    v_mov_b32 v6, 0
    v_mov_b32 v7, 0
    v_mov_b32 v8, 0
    v_mov_b32 v9, 0
    v_mov_b32 v10, 0
    v_mov_b32 v11, 0
    v_mov_b32 v12, 0
    v_mov_b32 v13, 0
    v_mov_b32 v14, 0
    v_mov_b32 v15, 0
    v_mov_b32 v16, 0
    v_mov_b32 v17, 0
    v_mov_b32 v18, 0
    v_mov_b32 v19, 0
    v_mov_b32 v20, 0
    v_mov_b32 v21, 0
    v_mov_b32 v22, 0
    v_mov_b32 v23, 0
    v_mov_b32 v24, 0
    v_mov_b32 v25, 0
    v_mov_b32 v26, 0
    v_mov_b32 v27, 0
    v_mov_b32 v28, 0
    v_mov_b32 v29, 0
    v_mov_b32 v30, 0
    v_mov_b32 v31, 0
    s_cmp_eq_u32 s22, 0
    s_cbranch_scc0 m_ho_p
    s_lshl_b32 s38, s20, 7
    s_add_u32 s38, s38, s66
    s_add_u32 s38, s38, 2048
    v_and_b32 v250, 15, v255
    v_lshlrev_b32 v250, 3, v250
    s_mov_b32 s39, 65536
    s_not_b32 s71, s69
    buffer_load_dwordx2 v[248:249], v250, s[8:11], s38 offen sc1
poll5:
    s_waitcnt vmcnt(0)
    v_cmp_eq_u32 vcc, s69, v248
    v_cmp_eq_u32 s[72:73], s71, v249
    s_nop 0
    s_and_b64 vcc, vcc, s[72:73]
    s_cmp_eq_u64 vcc, exec
    s_cbranch_scc1 poll5_done
    buffer_load_dwordx2 v[248:249], v250, s[8:11], s38 offen sc1
    s_sub_u32 s39, s39, 1
    s_cmp_lg_u32 s39, 0
    s_cbranch_scc1 poll5
poll5_done:
m_ho_p:
    s_barrier
    s_add_u32 s55, s54, 0
    buffer_load_dwordx4 v[32:35], v254, s[8:11], s55 offen offset:0 sc1
    buffer_load_dwordx4 v[36:39], v254, s[8:11], s55 offen offset:1024 sc1
    buffer_load_dwordx4 v[40:43], v254, s[8:11], s55 offen offset:2048 sc1
    buffer_load_dwordx4 v[44:47], v254, s[8:11], s55 offen offset:3072 sc1
    s_add_u32 s55, s54, 4096
    buffer_load_dwordx4 v[48:51], v254, s[8:11], s55 offen offset:0 sc1
    buffer_load_dwordx4 v[52:55], v254, s[8:11], s55 offen offset:1024 sc1
    buffer_load_dwordx4 v[56:59], v254, s[8:11], s55 offen offset:2048 sc1
    buffer_load_dwordx4 v[60:63], v254, s[8:11], s55 offen offset:3072 sc1
    s_add_u32 s55, s54, 8192
    buffer_load_dwordx4 v[64:67], v254, s[8:11], s55 offen offset:0 sc1
    buffer_load_dwordx4 v[68:71], v254, s[8:11], s55 offen offset:1024 sc1
    buffer_load_dwordx4 v[72:75], v254, s[8:11], s55 offen offset:2048 sc1
    buffer_load_dwordx4 v[76:79], v254, s[8:11], s55 offen offset:3072 sc1
    s_add_u32 s55, s54, 12288
    buffer_load_dwordx4 v[80:83], v254, s[8:11], s55 offen offset:0 sc1
    buffer_load_dwordx4 v[84:87], v254, s[8:11], s55 offen offset:1024 sc1
    buffer_load_dwordx4 v[88:91], v254, s[8:11], s55 offen offset:2048 sc1
    buffer_load_dwordx4 v[92:95], v254, s[8:11], s55 offen offset:3072 sc1
    ds_read_b64_tr_b16 v[96:97], v128 offset:0
    ds_read_b64_tr_b16 v[98:99], v128 offset:1024
    ds_read_b64_tr_b16 v[100:101], v129 offset:0
    ds_read_b64_tr_b16 v[102:103], v129 offset:1024
    s_waitcnt vmcnt(15) lgkmcnt(2)
    v_mfma_f32_32x32x16_bf16 v[0:15], v[96:99], v[32:35], v[0:15]
    ds_read_b64_tr_b16 v[104:105], v128 offset:2048
    ds_read_b64_tr_b16 v[106:107], v128 offset:3072
    s_waitcnt lgkmcnt(2)
    v_mfma_f32_32x32x16_bf16 v[16:31], v[100:103], v[32:35], v[16:31]
    ds_read_b64_tr_b16 v[108:109], v129 offset:2048
    ds_read_b64_tr_b16 v[110:111], v129 offset:3072
    s_add_u32 s55, s54, 32768
    buffer_load_dwordx4 v[32:35], v254, s[8:11], s55 offen offset:0 sc1
    s_waitcnt vmcnt(15) lgkmcnt(2)
    v_mfma_f32_32x32x16_bf16 v[0:15], v[104:107], v[36:39], v[0:15]
    ds_read_b64_tr_b16 v[96:97], v128 offset:4096
    ds_read_b64_tr_b16 v[98:99], v128 offset:5120
    s_waitcnt lgkmcnt(2)
    v_mfma_f32_32x32x16_bf16 v[16:31], v[108:111], v[36:39], v[16:31]
    ds_read_b64_tr_b16 v[100:101], v129 offset:4096
    ds_read_b64_tr_b16 v[102:103], v129 offset:5120
    buffer_load_dwordx4 v[36:39], v254, s[8:11], s55 offen offset:1024 sc1
    s_waitcnt vmcnt(15) lgkmcnt(2)
    v_mfma_f32_32x32x16_bf16 v[0:15], v[96:99], v[40:43], v[0:15]
    ds_read_b64_tr_b16 v[104:105], v128 offset:6144
    ds_read_b64_tr_b16 v[106:107], v128 offset:7168
    s_waitcnt lgkmcnt(2)
    v_mfma_f32_32x32x16_bf16 v[16:31], v[100:103], v[40:43], v[16:31]
    ds_read_b64_tr_b16 v[108:109], v129 offset:6144
    ds_read_b64_tr_b16 v[110:111], v129 offset:7168
    buffer_load_dwordx4 v[40:43], v254, s[8:11], s55 offen offset:2048 sc1
    s_waitcnt vmcnt(15) lgkmcnt(2)
    v_mfma_f32_32x32x16_bf16 v[0:15], v[104:107], v[44:47], v[0:15]
    ds_read_b64_tr_b16 v[96:97], v128 offset:8192
    ds_read_b64_tr_b16 v[98:99], v128 offset:9216
    s_waitcnt lgkmcnt(2)
    v_mfma_f32_32x32x16_bf16 v[16:31], v[108:111], v[44:47], v[16:31]
    ds_read_b64_tr_b16 v[100:101], v129 offset:8192
    ds_read_b64_tr_b16 v[102:103], v129 offset:9216
    buffer_load_dwordx4 v[44:47], v254, s[8:11], s55 offen offset:3072 sc1
    s_waitcnt vmcnt(15) lgkmcnt(2)
    v_mfma_f32_32x32x16_bf16 v[0:15], v[96:99], v[48:51], v[0:15]
    ds_read_b64_tr_b16 v[104:105], v128 offset:10240
    ds_read_b64_tr_b16 v[106:107], v128 offset:11264
    s_waitcnt lgkmcnt(2)
    v_mfma_f32_32x32x16_bf16 v[16:31], v[100:103], v[48:51], v[16:31]
    ds_read_b64_tr_b16 v[108:109], v129 offset:10240
    ds_read_b64_tr_b16 v[110:111], v129 offset:11264
    s_add_u32 s55, s54, 36864
    buffer_load_dwordx4 v[48:51], v254, s[8:11], s55 offen offset:0 sc1
    s_waitcnt vmcnt(15) lgkmcnt(2)
    v_mfma_f32_32x32x16_bf16 v[0:15], v[104:107], v[52:55], v[0:15]
    ds_read_b64_tr_b16 v[96:97], v128 offset:12288
    ds_read_b64_tr_b16 v[98:99], v128 offset:13312
    s_waitcnt lgkmcnt(2)
    v_mfma_f32_32x32x16_bf16 v[16:31], v[108:111], v[52:55], v[16:31]
    ds_read_b64_tr_b16 v[100:101], v129 offset:12288
    ds_read_b64_tr_b16 v[102:103], v129 offset:13312
    buffer_load_dwordx4 v[52:55], v254, s[8:11], s55 offen offset:1024 sc1
    s_waitcnt vmcnt(15) lgkmcnt(2)
    v_mfma_f32_32x32x16_bf16 v[0:15], v[96:99], v[56:59], v[0:15]
    ds_read_b64_tr_b16 v[104:105], v128 offset:14336
    ds_read_b64_tr_b16 v[106:107], v128 offset:15360
    s_waitcnt lgkmcnt(2)
    v_mfma_f32_32x32x16_bf16 v[16:31], v[100:103], v[56:59], v[16:31]
    ds_read_b64_tr_b16 v[108:109], v129 offset:14336
    ds_read_b64_tr_b16 v[110:111], v129 offset:15360
    buffer_load_dwordx4 v[56:59], v254, s[8:11], s55 offen offset:2048 sc1
    s_waitcnt vmcnt(15) lgkmcnt(2)
    v_mfma_f32_32x32x16_bf16 v[0:15], v[104:107], v[60:63], v[0:15]
    ds_read_b64_tr_b16 v[96:97], v128 offset:16384
    ds_read_b64_tr_b16 v[98:99], v128 offset:17408
    s_waitcnt lgkmcnt(2)
    v_mfma_f32_32x32x16_bf16 v[16:31], v[108:111], v[60:63], v[16:31]
    ds_read_b64_tr_b16 v[100:101], v129 offset:16384
    ds_read_b64_tr_b16 v[102:103], v129 offset:17408
    buffer_load_dwordx4 v[60:63], v254, s[8:11], s55 offen offset:3072 sc1
    s_waitcnt vmcnt(15) lgkmcnt(2)
    v_mfma_f32_32x32x16_bf16 v[0:15], v[96:99], v[64:67], v[0:15]
    ds_read_b64_tr_b16 v[104:105], v128 offset:18432
    ds_read_b64_tr_b16 v[106:107], v128 offset:19456
    s_waitcnt lgkmcnt(2)
    v_mfma_f32_32x32x16_bf16 v[16:31], v[100:103], v[64:67], v[16:31]
    ds_read_b64_tr_b16 v[108:109], v129 offset:18432
    ds_read_b64_tr_b16 v[110:111], v129 offset:19456
    s_add_u32 s55, s54, 40960
    buffer_load_dwordx4 v[64:67], v254, s[8:11], s55 offen offset:0 sc1
    s_waitcnt vmcnt(15) lgkmcnt(2)
    v_mfma_f32_32x32x16_bf16 v[0:15], v[104:107], v[68:71], v[0:15]
    ds_read_b64_tr_b16 v[96:97], v128 offset:20480
    ds_read_b64_tr_b16 v[98:99], v128 offset:21504
    s_waitcnt lgkmcnt(2)
    v_mfma_f32_32x32x16_bf16 v[16:31], v[108:111], v[68:71], v[16:31]
    ds_read_b64_tr_b16 v[100:101], v129 offset:20480
    ds_read_b64_tr_b16 v[102:103], v129 offset:21504
    buffer_load_dwordx4 v[68:71], v254, s[8:11], s55 offen offset:1024 sc1
    s_waitcnt vmcnt(15) lgkmcnt(2)
    v_mfma_f32_32x32x16_bf16 v[0:15], v[96:99], v[72:75], v[0:15]
    ds_read_b64_tr_b16 v[104:105], v128 offset:22528
    ds_read_b64_tr_b16 v[106:107], v128 offset:23552
    s_waitcnt lgkmcnt(2)
    v_mfma_f32_32x32x16_bf16 v[16:31], v[100:103], v[72:75], v[16:31]
    ds_read_b64_tr_b16 v[108:109], v129 offset:22528
    ds_read_b64_tr_b16 v[110:111], v129 offset:23552
    buffer_load_dwordx4 v[72:75], v254, s[8:11], s55 offen offset:2048 sc1
    s_waitcnt vmcnt(15) lgkmcnt(2)
    v_mfma_f32_32x32x16_bf16 v[0:15], v[104:107], v[76:79], v[0:15]
    ds_read_b64_tr_b16 v[96:97], v128 offset:24576
    ds_read_b64_tr_b16 v[98:99], v128 offset:25600
    s_waitcnt lgkmcnt(2)
    v_mfma_f32_32x32x16_bf16 v[16:31], v[108:111], v[76:79], v[16:31]
    ds_read_b64_tr_b16 v[100:101], v129 offset:24576
    ds_read_b64_tr_b16 v[102:103], v129 offset:25600
    buffer_load_dwordx4 v[76:79], v254, s[8:11], s55 offen offset:3072 sc1
    s_waitcnt vmcnt(15) lgkmcnt(2)
    v_mfma_f32_32x32x16_bf16 v[0:15], v[96:99], v[80:83], v[0:15]
    ds_read_b64_tr_b16 v[104:105], v128 offset:26624
    ds_read_b64_tr_b16 v[106:107], v128 offset:27648
    s_waitcnt lgkmcnt(2)
    v_mfma_f32_32x32x16_bf16 v[16:31], v[100:103], v[80:83], v[16:31]
    ds_read_b64_tr_b16 v[108:109], v129 offset:26624
    ds_read_b64_tr_b16 v[110:111], v129 offset:27648
    s_add_u32 s55, s54, 45056
    buffer_load_dwordx4 v[80:83], v254, s[8:11], s55 offen offset:0 sc1
    s_waitcnt vmcnt(15) lgkmcnt(2)
    v_mfma_f32_32x32x16_bf16 v[0:15], v[104:107], v[84:87], v[0:15]
    ds_read_b64_tr_b16 v[96:97], v128 offset:28672
    ds_read_b64_tr_b16 v[98:99], v128 offset:29696
    s_waitcnt lgkmcnt(2)
    v_mfma_f32_32x32x16_bf16 v[16:31], v[108:111], v[84:87], v[16:31]
    ds_read_b64_tr_b16 v[100:101], v129 offset:28672
    ds_read_b64_tr_b16 v[102:103], v129 offset:29696
    buffer_load_dwordx4 v[84:87], v254, s[8:11], s55 offen offset:1024 sc1
    s_waitcnt vmcnt(15) lgkmcnt(2)
    v_mfma_f32_32x32x16_bf16 v[0:15], v[96:99], v[88:91], v[0:15]
    ds_read_b64_tr_b16 v[104:105], v128 offset:30720
    ds_read_b64_tr_b16 v[106:107], v128 offset:31744
    s_waitcnt lgkmcnt(2)
    v_mfma_f32_32x32x16_bf16 v[16:31], v[100:103], v[88:91], v[16:31]
    ds_read_b64_tr_b16 v[108:109], v129 offset:30720
    ds_read_b64_tr_b16 v[110:111], v129 offset:31744
    buffer_load_dwordx4 v[88:91], v254, s[8:11], s55 offen offset:2048 sc1
    s_waitcnt vmcnt(15) lgkmcnt(2)
    v_mfma_f32_32x32x16_bf16 v[0:15], v[104:107], v[92:95], v[0:15]
    ds_read_b64_tr_b16 v[96:97], v130 offset:0
    ds_read_b64_tr_b16 v[98:99], v130 offset:1024
    s_waitcnt lgkmcnt(2)
    v_mfma_f32_32x32x16_bf16 v[16:31], v[108:111], v[92:95], v[16:31]
    ds_read_b64_tr_b16 v[100:101], v131 offset:0
    ds_read_b64_tr_b16 v[102:103], v131 offset:1024
    buffer_load_dwordx4 v[92:95], v254, s[8:11], s55 offen offset:3072 sc1
    s_waitcnt vmcnt(15) lgkmcnt(2)
    v_mfma_f32_32x32x16_bf16 v[0:15], v[96:99], v[32:35], v[0:15]
    ds_read_b64_tr_b16 v[104:105], v130 offset:2048
    ds_read_b64_tr_b16 v[106:107], v130 offset:3072
    s_waitcnt lgkmcnt(2)
    v_mfma_f32_32x32x16_bf16 v[16:31], v[100:103], v[32:35], v[16:31]
    ds_read_b64_tr_b16 v[108:109], v131 offset:2048
    ds_read_b64_tr_b16 v[110:111], v131 offset:3072
    s_add_u32 s55, s54, 16384
    buffer_load_dwordx4 v[32:35], v254, s[8:11], s55 offen offset:0 sc1
    s_waitcnt vmcnt(15) lgkmcnt(2)
    v_mfma_f32_32x32x16_bf16 v[0:15], v[104:107], v[36:39], v[0:15]
    ds_read_b64_tr_b16 v[96:97], v130 offset:4096
    ds_read_b64_tr_b16 v[98:99], v130 offset:5120
    s_waitcnt lgkmcnt(2)
    v_mfma_f32_32x32x16_bf16 v[16:31], v[108:111], v[36:39], v[16:31]
    ds_read_b64_tr_b16 v[100:101], v131 offset:4096
    ds_read_b64_tr_b16 v[102:103], v131 offset:5120
    buffer_load_dwordx4 v[36:39], v254, s[8:11], s55 offen offset:1024 sc1
    s_waitcnt vmcnt(15) lgkmcnt(2)
    v_mfma_f32_32x32x16_bf16 v[0:15], v[96:99], v[40:43], v[0:15]
    ds_read_b64_tr_b16 v[104:105], v130 offset:6144
    ds_read_b64_tr_b16 v[106:107], v130 offset:7168
    s_waitcnt lgkmcnt(2)
    v_mfma_f32_32x32x16_bf16 v[16:31], v[100:103], v[40:43], v[16:31]
    ds_read_b64_tr_b16 v[108:109], v131 offset:6144
    ds_read_b64_tr_b16 v[110:111], v131 offset:7168
    buffer_load_dwordx4 v[40:43], v254, s[8:11], s55 offen offset:2048 sc1
    s_waitcnt vmcnt(15) lgkmcnt(2)
    v_mfma_f32_32x32x16_bf16 v[0:15], v[104:107], v[44:47], v[0:15]
    ds_read_b64_tr_b16 v[96:97], v130 offset:8192
    ds_read_b64_tr_b16 v[98:99], v130 offset:9216
    s_waitcnt lgkmcnt(2)
    v_mfma_f32_32x32x16_bf16 v[16:31], v[108:111], v[44:47], v[16:31]
    ds_read_b64_tr_b16 v[100:101], v131 offset:8192
    ds_read_b64_tr_b16 v[102:103], v131 offset:9216
    buffer_load_dwordx4 v[44:47], v254, s[8:11], s55 offen offset:3072 sc1
    s_waitcnt vmcnt(15) lgkmcnt(2)
    v_mfma_f32_32x32x16_bf16 v[0:15], v[96:99], v[48:51], v[0:15]
    ds_read_b64_tr_b16 v[104:105], v130 offset:10240
    ds_read_b64_tr_b16 v[106:107], v130 offset:11264
    s_waitcnt lgkmcnt(2)
    v_mfma_f32_32x32x16_bf16 v[16:31], v[100:103], v[48:51], v[16:31]
    ds_read_b64_tr_b16 v[108:109], v131 offset:10240
    ds_read_b64_tr_b16 v[110:111], v131 offset:11264
    s_add_u32 s55, s54, 20480
    buffer_load_dwordx4 v[48:51], v254, s[8:11], s55 offen offset:0 sc1
    s_waitcnt vmcnt(15) lgkmcnt(2)
    v_mfma_f32_32x32x16_bf16 v[0:15], v[104:107], v[52:55], v[0:15]
    ds_read_b64_tr_b16 v[96:97], v130 offset:12288
    ds_read_b64_tr_b16 v[98:99], v130 offset:13312
    s_waitcnt lgkmcnt(2)
    v_mfma_f32_32x32x16_bf16 v[16:31], v[108:111], v[52:55], v[16:31]
    ds_read_b64_tr_b16 v[100:101], v131 offset:12288
    ds_read_b64_tr_b16 v[102:103], v131 offset:13312
    buffer_load_dwordx4 v[52:55], v254, s[8:11], s55 offen offset:1024 sc1
    s_waitcnt vmcnt(15) lgkmcnt(2)
    v_mfma_f32_32x32x16_bf16 v[0:15], v[96:99], v[56:59], v[0:15]
    ds_read_b64_tr_b16 v[104:105], v130 offset:14336
    ds_read_b64_tr_b16 v[106:107], v130 offset:15360
    s_waitcnt lgkmcnt(2)
    v_mfma_f32_32x32x16_bf16 v[16:31], v[100:103], v[56:59], v[16:31]
    ds_read_b64_tr_b16 v[108:109], v131 offset:14336
    ds_read_b64_tr_b16 v[110:111], v131 offset:15360
    buffer_load_dwordx4 v[56:59], v254, s[8:11], s55 offen offset:2048 sc1
    s_waitcnt vmcnt(15) lgkmcnt(2)
    v_mfma_f32_32x32x16_bf16 v[0:15], v[104:107], v[60:63], v[0:15]
    ds_read_b64_tr_b16 v[96:97], v130 offset:16384
    ds_read_b64_tr_b16 v[98:99], v130 offset:17408
    s_waitcnt lgkmcnt(2)
    v_mfma_f32_32x32x16_bf16 v[16:31], v[108:111], v[60:63], v[16:31]
    ds_read_b64_tr_b16 v[100:101], v131 offset:16384
    ds_read_b64_tr_b16 v[102:103], v131 offset:17408
    buffer_load_dwordx4 v[60:63], v254, s[8:11], s55 offen offset:3072 sc1
    s_waitcnt vmcnt(15) lgkmcnt(2)
    v_mfma_f32_32x32x16_bf16 v[0:15], v[96:99], v[64:67], v[0:15]
    ds_read_b64_tr_b16 v[104:105], v130 offset:18432
    ds_read_b64_tr_b16 v[106:107], v130 offset:19456
    s_waitcnt lgkmcnt(2)
    v_mfma_f32_32x32x16_bf16 v[16:31], v[100:103], v[64:67], v[16:31]
    ds_read_b64_tr_b16 v[108:109], v131 offset:18432
    ds_read_b64_tr_b16 v[110:111], v131 offset:19456
    s_add_u32 s55, s54, 24576
    buffer_load_dwordx4 v[64:67], v254, s[8:11], s55 offen offset:0 sc1
    s_waitcnt vmcnt(15) lgkmcnt(2)
    v_mfma_f32_32x32x16_bf16 v[0:15], v[104:107], v[68:71], v[0:15]
    ds_read_b64_tr_b16 v[96:97], v130 offset:20480
    ds_read_b64_tr_b16 v[98:99], v130 offset:21504
    s_waitcnt lgkmcnt(2)
    v_mfma_f32_32x32x16_bf16 v[16:31], v[108:111], v[68:71], v[16:31]
    ds_read_b64_tr_b16 v[100:101], v131 offset:20480
    ds_read_b64_tr_b16 v[102:103], v131 offset:21504
    buffer_load_dwordx4 v[68:71], v254, s[8:11], s55 offen offset:1024 sc1
    s_waitcnt vmcnt(15) lgkmcnt(2)
    v_mfma_f32_32x32x16_bf16 v[0:15], v[96:99], v[72:75], v[0:15]
    ds_read_b64_tr_b16 v[104:105], v130 offset:22528
    ds_read_b64_tr_b16 v[106:107], v130 offset:23552
    s_waitcnt lgkmcnt(2)
    v_mfma_f32_32x32x16_bf16 v[16:31], v[100:103], v[72:75], v[16:31]
    ds_read_b64_tr_b16 v[108:109], v131 offset:22528
    ds_read_b64_tr_b16 v[110:111], v131 offset:23552
    buffer_load_dwordx4 v[72:75], v254, s[8:11], s55 offen offset:2048 sc1
    s_waitcnt vmcnt(15) lgkmcnt(2)
    v_mfma_f32_32x32x16_bf16 v[0:15], v[104:107], v[76:79], v[0:15]
    ds_read_b64_tr_b16 v[96:97], v130 offset:24576
    ds_read_b64_tr_b16 v[98:99], v130 offset:25600
    s_waitcnt lgkmcnt(2)
    v_mfma_f32_32x32x16_bf16 v[16:31], v[108:111], v[76:79], v[16:31]
    ds_read_b64_tr_b16 v[100:101], v131 offset:24576
    ds_read_b64_tr_b16 v[102:103], v131 offset:25600
    buffer_load_dwordx4 v[76:79], v254, s[8:11], s55 offen offset:3072 sc1
    s_waitcnt vmcnt(15) lgkmcnt(2)
    v_mfma_f32_32x32x16_bf16 v[0:15], v[96:99], v[80:83], v[0:15]
    ds_read_b64_tr_b16 v[104:105], v130 offset:26624
    ds_read_b64_tr_b16 v[106:107], v130 offset:27648
    s_waitcnt lgkmcnt(2)
    v_mfma_f32_32x32x16_bf16 v[16:31], v[100:103], v[80:83], v[16:31]
    ds_read_b64_tr_b16 v[108:109], v131 offset:26624
    ds_read_b64_tr_b16 v[110:111], v131 offset:27648
    s_add_u32 s55, s54, 28672
    buffer_load_dwordx4 v[80:83], v254, s[8:11], s55 offen offset:0 sc1
    s_waitcnt vmcnt(15) lgkmcnt(2)
    v_mfma_f32_32x32x16_bf16 v[0:15], v[104:107], v[84:87], v[0:15]
    ds_read_b64_tr_b16 v[96:97], v130 offset:28672
    ds_read_b64_tr_b16 v[98:99], v130 offset:29696
    s_waitcnt lgkmcnt(2)
    v_mfma_f32_32x32x16_bf16 v[16:31], v[108:111], v[84:87], v[16:31]
    ds_read_b64_tr_b16 v[100:101], v131 offset:28672
    ds_read_b64_tr_b16 v[102:103], v131 offset:29696
    buffer_load_dwordx4 v[84:87], v254, s[8:11], s55 offen offset:1024 sc1
    s_waitcnt vmcnt(15) lgkmcnt(2)
    v_mfma_f32_32x32x16_bf16 v[0:15], v[96:99], v[88:91], v[0:15]
    ds_read_b64_tr_b16 v[104:105], v130 offset:30720
    ds_read_b64_tr_b16 v[106:107], v130 offset:31744
    s_waitcnt lgkmcnt(2)
    v_mfma_f32_32x32x16_bf16 v[16:31], v[100:103], v[88:91], v[16:31]
    ds_read_b64_tr_b16 v[108:109], v131 offset:30720
    ds_read_b64_tr_b16 v[110:111], v131 offset:31744
    buffer_load_dwordx4 v[88:91], v254, s[8:11], s55 offen offset:2048 sc1
    s_waitcnt vmcnt(15) lgkmcnt(2)
    v_mfma_f32_32x32x16_bf16 v[0:15], v[104:107], v[92:95], v[0:15]
    s_barrier
    ds_read_b64_tr_b16 v[96:97], v128 offset:32768
    ds_read_b64_tr_b16 v[98:99], v128 offset:33792
    s_waitcnt lgkmcnt(2)
    v_mfma_f32_32x32x16_bf16 v[16:31], v[108:111], v[92:95], v[16:31]
    ds_read_b64_tr_b16 v[100:101], v129 offset:32768
    ds_read_b64_tr_b16 v[102:103], v129 offset:33792
    buffer_load_dwordx4 v[92:95], v254, s[8:11], s55 offen offset:3072 sc1
    s_waitcnt vmcnt(15) lgkmcnt(2)
    v_mfma_f32_32x32x16_bf16 v[0:15], v[96:99], v[32:35], v[0:15]
    ds_read_b64_tr_b16 v[104:105], v128 offset:34816
    ds_read_b64_tr_b16 v[106:107], v128 offset:35840
    s_waitcnt lgkmcnt(2)
    v_mfma_f32_32x32x16_bf16 v[16:31], v[100:103], v[32:35], v[16:31]
    ds_read_b64_tr_b16 v[108:109], v129 offset:34816
    ds_read_b64_tr_b16 v[110:111], v129 offset:35840
    s_add_u32 s55, s54, 49152
    buffer_load_dwordx4 v[32:35], v254, s[8:11], s55 offen offset:0 sc1
    s_waitcnt vmcnt(15) lgkmcnt(2)
    v_mfma_f32_32x32x16_bf16 v[0:15], v[104:107], v[36:39], v[0:15]
    ds_read_b64_tr_b16 v[96:97], v128 offset:36864
    ds_read_b64_tr_b16 v[98:99], v128 offset:37888
    s_waitcnt lgkmcnt(2)
    v_mfma_f32_32x32x16_bf16 v[16:31], v[108:111], v[36:39], v[16:31]
    ds_read_b64_tr_b16 v[100:101], v129 offset:36864
    ds_read_b64_tr_b16 v[102:103], v129 offset:37888
    buffer_load_dwordx4 v[36:39], v254, s[8:11], s55 offen offset:1024 sc1
    s_waitcnt vmcnt(15) lgkmcnt(2)
    v_mfma_f32_32x32x16_bf16 v[0:15], v[96:99], v[40:43], v[0:15]
    ds_read_b64_tr_b16 v[104:105], v128 offset:38912
    ds_read_b64_tr_b16 v[106:107], v128 offset:39936
    s_waitcnt lgkmcnt(2)
    v_mfma_f32_32x32x16_bf16 v[16:31], v[100:103], v[40:43], v[16:31]
    ds_read_b64_tr_b16 v[108:109], v129 offset:38912
    ds_read_b64_tr_b16 v[110:111], v129 offset:39936
    buffer_load_dwordx4 v[40:43], v254, s[8:11], s55 offen offset:2048 sc1
    s_waitcnt vmcnt(15) lgkmcnt(2)
    v_mfma_f32_32x32x16_bf16 v[0:15], v[104:107], v[44:47], v[0:15]
    ds_read_b64_tr_b16 v[96:97], v128 offset:40960
    ds_read_b64_tr_b16 v[98:99], v128 offset:41984
    s_waitcnt lgkmcnt(2)
    v_mfma_f32_32x32x16_bf16 v[16:31], v[108:111], v[44:47], v[16:31]
    ds_read_b64_tr_b16 v[100:101], v129 offset:40960
    ds_read_b64_tr_b16 v[102:103], v129 offset:41984
    buffer_load_dwordx4 v[44:47], v254, s[8:11], s55 offen offset:3072 sc1
    s_waitcnt vmcnt(15) lgkmcnt(2)
    v_mfma_f32_32x32x16_bf16 v[0:15], v[96:99], v[48:51], v[0:15]
    ds_read_b64_tr_b16 v[104:105], v128 offset:43008
    ds_read_b64_tr_b16 v[106:107], v128 offset:44032
    s_waitcnt lgkmcnt(2)
    v_mfma_f32_32x32x16_bf16 v[16:31], v[100:103], v[48:51], v[16:31]
    ds_read_b64_tr_b16 v[108:109], v129 offset:43008
    ds_read_b64_tr_b16 v[110:111], v129 offset:44032
    s_add_u32 s55, s54, 53248
    buffer_load_dwordx4 v[48:51], v254, s[8:11], s55 offen offset:0 sc1
    s_waitcnt vmcnt(15) lgkmcnt(2)
    v_mfma_f32_32x32x16_bf16 v[0:15], v[104:107], v[52:55], v[0:15]
    ds_read_b64_tr_b16 v[96:97], v128 offset:45056
    ds_read_b64_tr_b16 v[98:99], v128 offset:46080
    s_waitcnt lgkmcnt(2)
    v_mfma_f32_32x32x16_bf16 v[16:31], v[108:111], v[52:55], v[16:31]
    ds_read_b64_tr_b16 v[100:101], v129 offset:45056
    ds_read_b64_tr_b16 v[102:103], v129 offset:46080
    buffer_load_dwordx4 v[52:55], v254, s[8:11], s55 offen offset:1024 sc1
    s_waitcnt vmcnt(15) lgkmcnt(2)
    v_mfma_f32_32x32x16_bf16 v[0:15], v[96:99], v[56:59], v[0:15]
    ds_read_b64_tr_b16 v[104:105], v128 offset:47104
    ds_read_b64_tr_b16 v[106:107], v128 offset:48128
    s_waitcnt lgkmcnt(2)
    v_mfma_f32_32x32x16_bf16 v[16:31], v[100:103], v[56:59], v[16:31]
    ds_read_b64_tr_b16 v[108:109], v129 offset:47104
    ds_read_b64_tr_b16 v[110:111], v129 offset:48128
    buffer_load_dwordx4 v[56:59], v254, s[8:11], s55 offen offset:2048 sc1
    s_waitcnt vmcnt(15) lgkmcnt(2)
    v_mfma_f32_32x32x16_bf16 v[0:15], v[104:107], v[60:63], v[0:15]
    ds_read_b64_tr_b16 v[96:97], v128 offset:49152
    ds_read_b64_tr_b16 v[98:99], v128 offset:50176
    s_waitcnt lgkmcnt(2)
    v_mfma_f32_32x32x16_bf16 v[16:31], v[108:111], v[60:63], v[16:31]
    ds_read_b64_tr_b16 v[100:101], v129 offset:49152
    ds_read_b64_tr_b16 v[102:103], v129 offset:50176
    buffer_load_dwordx4 v[60:63], v254, s[8:11], s55 offen offset:3072 sc1
    s_waitcnt vmcnt(15) lgkmcnt(2)
    v_mfma_f32_32x32x16_bf16 v[0:15], v[96:99], v[64:67], v[0:15]
    ds_read_b64_tr_b16 v[104:105], v128 offset:51200
    ds_read_b64_tr_b16 v[106:107], v128 offset:52224
    s_waitcnt lgkmcnt(2)
    v_mfma_f32_32x32x16_bf16 v[16:31], v[100:103], v[64:67], v[16:31]
    ds_read_b64_tr_b16 v[108:109], v129 offset:51200
    ds_read_b64_tr_b16 v[110:111], v129 offset:52224
    s_add_u32 s55, s54, 57344
    buffer_load_dwordx4 v[64:67], v254, s[8:11], s55 offen offset:0 sc1
    s_waitcnt vmcnt(15) lgkmcnt(2)
    v_mfma_f32_32x32x16_bf16 v[0:15], v[104:107], v[68:71], v[0:15]
    ds_read_b64_tr_b16 v[96:97], v128 offset:53248
    ds_read_b64_tr_b16 v[98:99], v128 offset:54272
    s_waitcnt lgkmcnt(2)
    v_mfma_f32_32x32x16_bf16 v[16:31], v[108:111], v[68:71], v[16:31]
    ds_read_b64_tr_b16 v[100:101], v129 offset:53248
    ds_read_b64_tr_b16 v[102:103], v129 offset:54272
    buffer_load_dwordx4 v[68:71], v254, s[8:11], s55 offen offset:1024 sc1
    s_waitcnt vmcnt(15) lgkmcnt(2)
    v_mfma_f32_32x32x16_bf16 v[0:15], v[96:99], v[72:75], v[0:15]
    ds_read_b64_tr_b16 v[104:105], v128 offset:55296
    ds_read_b64_tr_b16 v[106:107], v128 offset:56320
    s_waitcnt lgkmcnt(2)
    v_mfma_f32_32x32x16_bf16 v[16:31], v[100:103], v[72:75], v[16:31]
    ds_read_b64_tr_b16 v[108:109], v129 offset:55296
    ds_read_b64_tr_b16 v[110:111], v129 offset:56320
    buffer_load_dwordx4 v[72:75], v254, s[8:11], s55 offen offset:2048 sc1
    s_waitcnt vmcnt(15) lgkmcnt(2)
    v_mfma_f32_32x32x16_bf16 v[0:15], v[104:107], v[76:79], v[0:15]
    ds_read_b64_tr_b16 v[96:97], v128 offset:57344
    ds_read_b64_tr_b16 v[98:99], v128 offset:58368
    s_waitcnt lgkmcnt(2)
    v_mfma_f32_32x32x16_bf16 v[16:31], v[108:111], v[76:79], v[16:31]
    ds_read_b64_tr_b16 v[100:101], v129 offset:57344
    ds_read_b64_tr_b16 v[102:103], v129 offset:58368
    buffer_load_dwordx4 v[76:79], v254, s[8:11], s55 offen offset:3072 sc1
    s_waitcnt vmcnt(15) lgkmcnt(2)
    v_mfma_f32_32x32x16_bf16 v[0:15], v[96:99], v[80:83], v[0:15]
    ds_read_b64_tr_b16 v[104:105], v128 offset:59392
    ds_read_b64_tr_b16 v[106:107], v128 offset:60416
    s_waitcnt lgkmcnt(2)
    v_mfma_f32_32x32x16_bf16 v[16:31], v[100:103], v[80:83], v[16:31]
    ds_read_b64_tr_b16 v[108:109], v129 offset:59392
    ds_read_b64_tr_b16 v[110:111], v129 offset:60416
    s_add_u32 s55, s54, 61440
    buffer_load_dwordx4 v[80:83], v254, s[8:11], s55 offen offset:0 sc1
    s_waitcnt vmcnt(15) lgkmcnt(2)
    v_mfma_f32_32x32x16_bf16 v[0:15], v[104:107], v[84:87], v[0:15]
    ds_read_b64_tr_b16 v[96:97], v128 offset:61440
    ds_read_b64_tr_b16 v[98:99], v128 offset:62464
    s_waitcnt lgkmcnt(2)
    v_mfma_f32_32x32x16_bf16 v[16:31], v[108:111], v[84:87], v[16:31]
    ds_read_b64_tr_b16 v[100:101], v129 offset:61440
    ds_read_b64_tr_b16 v[102:103], v129 offset:62464
    buffer_load_dwordx4 v[84:87], v254, s[8:11], s55 offen offset:1024 sc1
    s_waitcnt vmcnt(15) lgkmcnt(2)
    v_mfma_f32_32x32x16_bf16 v[0:15], v[96:99], v[88:91], v[0:15]
    ds_read_b64_tr_b16 v[104:105], v128 offset:63488
    ds_read_b64_tr_b16 v[106:107], v128 offset:64512
    s_waitcnt lgkmcnt(2)
    v_mfma_f32_32x32x16_bf16 v[16:31], v[100:103], v[88:91], v[16:31]
    ds_read_b64_tr_b16 v[108:109], v129 offset:63488
    ds_read_b64_tr_b16 v[110:111], v129 offset:64512
    buffer_load_dwordx4 v[88:91], v254, s[8:11], s55 offen offset:2048 sc1
    s_waitcnt vmcnt(15) lgkmcnt(2)
    v_mfma_f32_32x32x16_bf16 v[0:15], v[104:107], v[92:95], v[0:15]
    ds_read_b64_tr_b16 v[96:97], v130 offset:32768
    ds_read_b64_tr_b16 v[98:99], v130 offset:33792
    s_waitcnt lgkmcnt(2)
    v_mfma_f32_32x32x16_bf16 v[16:31], v[108:111], v[92:95], v[16:31]
    ds_read_b64_tr_b16 v[100:101], v131 offset:32768
    ds_read_b64_tr_b16 v[102:103], v131 offset:33792
    buffer_load_dwordx4 v[92:95], v254, s[8:11], s55 offen offset:3072 sc1
    s_waitcnt vmcnt(15) lgkmcnt(2)
    v_mfma_f32_32x32x16_bf16 v[0:15], v[96:99], v[32:35], v[0:15]
    ds_read_b64_tr_b16 v[104:105], v130 offset:34816
    ds_read_b64_tr_b16 v[106:107], v130 offset:35840
    s_waitcnt lgkmcnt(2)
    v_mfma_f32_32x32x16_bf16 v[16:31], v[100:103], v[32:35], v[16:31]
    ds_read_b64_tr_b16 v[108:109], v131 offset:34816
    ds_read_b64_tr_b16 v[110:111], v131 offset:35840
    s_waitcnt vmcnt(14) lgkmcnt(2)
    v_mfma_f32_32x32x16_bf16 v[0:15], v[104:107], v[36:39], v[0:15]
    ds_read_b64_tr_b16 v[96:97], v130 offset:36864
    ds_read_b64_tr_b16 v[98:99], v130 offset:37888
    s_waitcnt lgkmcnt(2)
    v_mfma_f32_32x32x16_bf16 v[16:31], v[108:111], v[36:39], v[16:31]
    ds_read_b64_tr_b16 v[100:101], v131 offset:36864
    ds_read_b64_tr_b16 v[102:103], v131 offset:37888
    s_waitcnt vmcnt(13) lgkmcnt(2)
    v_mfma_f32_32x32x16_bf16 v[0:15], v[96:99], v[40:43], v[0:15]
    ds_read_b64_tr_b16 v[104:105], v130 offset:38912
    ds_read_b64_tr_b16 v[106:107], v130 offset:39936
    s_waitcnt lgkmcnt(2)
    v_mfma_f32_32x32x16_bf16 v[16:31], v[100:103], v[40:43], v[16:31]
    ds_read_b64_tr_b16 v[108:109], v131 offset:38912
    ds_read_b64_tr_b16 v[110:111], v131 offset:39936
    s_waitcnt vmcnt(12) lgkmcnt(2)
    v_mfma_f32_32x32x16_bf16 v[0:15], v[104:107], v[44:47], v[0:15]
    ds_read_b64_tr_b16 v[96:97], v130 offset:40960
    ds_read_b64_tr_b16 v[98:99], v130 offset:41984
    s_waitcnt lgkmcnt(2)
    v_mfma_f32_32x32x16_bf16 v[16:31], v[108:111], v[44:47], v[16:31]
    ds_read_b64_tr_b16 v[100:101], v131 offset:40960
    ds_read_b64_tr_b16 v[102:103], v131 offset:41984
    s_waitcnt vmcnt(11) lgkmcnt(2)
    v_mfma_f32_32x32x16_bf16 v[0:15], v[96:99], v[48:51], v[0:15]
    ds_read_b64_tr_b16 v[104:105], v130 offset:43008
    ds_read_b64_tr_b16 v[106:107], v130 offset:44032
    s_waitcnt lgkmcnt(2)
    v_mfma_f32_32x32x16_bf16 v[16:31], v[100:103], v[48:51], v[16:31]
    ds_read_b64_tr_b16 v[108:109], v131 offset:43008
    ds_read_b64_tr_b16 v[110:111], v131 offset:44032
    s_waitcnt vmcnt(10) lgkmcnt(2)
    v_mfma_f32_32x32x16_bf16 v[0:15], v[104:107], v[52:55], v[0:15]
    ds_read_b64_tr_b16 v[96:97], v130 offset:45056
    ds_read_b64_tr_b16 v[98:99], v130 offset:46080
    s_waitcnt lgkmcnt(2)
    v_mfma_f32_32x32x16_bf16 v[16:31], v[108:111], v[52:55], v[16:31]
    ds_read_b64_tr_b16 v[100:101], v131 offset:45056
    ds_read_b64_tr_b16 v[102:103], v131 offset:46080
    s_waitcnt vmcnt(9) lgkmcnt(2)
    v_mfma_f32_32x32x16_bf16 v[0:15], v[96:99], v[56:59], v[0:15]
    ds_read_b64_tr_b16 v[104:105], v130 offset:47104
    ds_read_b64_tr_b16 v[106:107], v130 offset:48128
    s_waitcnt lgkmcnt(2)
    v_mfma_f32_32x32x16_bf16 v[16:31], v[100:103], v[56:59], v[16:31]
    ds_read_b64_tr_b16 v[108:109], v131 offset:47104
    ds_read_b64_tr_b16 v[110:111], v131 offset:48128
    s_waitcnt vmcnt(8) lgkmcnt(2)
    v_mfma_f32_32x32x16_bf16 v[0:15], v[104:107], v[60:63], v[0:15]
    ds_read_b64_tr_b16 v[96:97], v130 offset:49152
    ds_read_b64_tr_b16 v[98:99], v130 offset:50176
    s_waitcnt lgkmcnt(2)
    v_mfma_f32_32x32x16_bf16 v[16:31], v[108:111], v[60:63], v[16:31]
    ds_read_b64_tr_b16 v[100:101], v131 offset:49152
    ds_read_b64_tr_b16 v[102:103], v131 offset:50176
    s_waitcnt vmcnt(7) lgkmcnt(2)
    v_mfma_f32_32x32x16_bf16 v[0:15], v[96:99], v[64:67], v[0:15]
    ds_read_b64_tr_b16 v[104:105], v130 offset:51200
    ds_read_b64_tr_b16 v[106:107], v130 offset:52224
    s_waitcnt lgkmcnt(2)
    v_mfma_f32_32x32x16_bf16 v[16:31], v[100:103], v[64:67], v[16:31]
    ds_read_b64_tr_b16 v[108:109], v131 offset:51200
    ds_read_b64_tr_b16 v[110:111], v131 offset:52224
    s_waitcnt vmcnt(6) lgkmcnt(2)
    v_mfma_f32_32x32x16_bf16 v[0:15], v[104:107], v[68:71], v[0:15]
    ds_read_b64_tr_b16 v[96:97], v130 offset:53248
    ds_read_b64_tr_b16 v[98:99], v130 offset:54272
    s_waitcnt lgkmcnt(2)
    v_mfma_f32_32x32x16_bf16 v[16:31], v[108:111], v[68:71], v[16:31]
    ds_read_b64_tr_b16 v[100:101], v131 offset:53248
    ds_read_b64_tr_b16 v[102:103], v131 offset:54272
    s_waitcnt vmcnt(5) lgkmcnt(2)
    v_mfma_f32_32x32x16_bf16 v[0:15], v[96:99], v[72:75], v[0:15]
    ds_read_b64_tr_b16 v[104:105], v130 offset:55296
    ds_read_b64_tr_b16 v[106:107], v130 offset:56320
    s_waitcnt lgkmcnt(2)
    v_mfma_f32_32x32x16_bf16 v[16:31], v[100:103], v[72:75], v[16:31]
    ds_read_b64_tr_b16 v[108:109], v131 offset:55296
    ds_read_b64_tr_b16 v[110:111], v131 offset:56320
    s_waitcnt vmcnt(4) lgkmcnt(2)
    v_mfma_f32_32x32x16_bf16 v[0:15], v[104:107], v[76:79], v[0:15]
    ds_read_b64_tr_b16 v[96:97], v130 offset:57344
    ds_read_b64_tr_b16 v[98:99], v130 offset:58368
    s_waitcnt lgkmcnt(2)
    v_mfma_f32_32x32x16_bf16 v[16:31], v[108:111], v[76:79], v[16:31]
    ds_read_b64_tr_b16 v[100:101], v131 offset:57344
    ds_read_b64_tr_b16 v[102:103], v131 offset:58368
    s_waitcnt vmcnt(3) lgkmcnt(2)
    v_mfma_f32_32x32x16_bf16 v[0:15], v[96:99], v[80:83], v[0:15]
    ds_read_b64_tr_b16 v[104:105], v130 offset:59392
    ds_read_b64_tr_b16 v[106:107], v130 offset:60416
    s_waitcnt lgkmcnt(2)
    v_mfma_f32_32x32x16_bf16 v[16:31], v[100:103], v[80:83], v[16:31]
    ds_read_b64_tr_b16 v[108:109], v131 offset:59392
    ds_read_b64_tr_b16 v[110:111], v131 offset:60416
    s_waitcnt vmcnt(2) lgkmcnt(2)
    v_mfma_f32_32x32x16_bf16 v[0:15], v[104:107], v[84:87], v[0:15]
    ds_read_b64_tr_b16 v[96:97], v130 offset:61440
    ds_read_b64_tr_b16 v[98:99], v130 offset:62464
    s_waitcnt lgkmcnt(2)
    v_mfma_f32_32x32x16_bf16 v[16:31], v[108:111], v[84:87], v[16:31]
    ds_read_b64_tr_b16 v[100:101], v131 offset:61440
    ds_read_b64_tr_b16 v[102:103], v131 offset:62464
    s_waitcnt vmcnt(1) lgkmcnt(2)
    v_mfma_f32_32x32x16_bf16 v[0:15], v[96:99], v[88:91], v[0:15]
    ds_read_b64_tr_b16 v[104:105], v130 offset:63488
    ds_read_b64_tr_b16 v[106:107], v130 offset:64512
    s_waitcnt lgkmcnt(2)
    v_mfma_f32_32x32x16_bf16 v[16:31], v[100:103], v[88:91], v[16:31]
    ds_read_b64_tr_b16 v[108:109], v131 offset:63488
    ds_read_b64_tr_b16 v[110:111], v131 offset:64512
    s_waitcnt vmcnt(0) lgkmcnt(2)
    v_mfma_f32_32x32x16_bf16 v[0:15], v[104:107], v[92:95], v[0:15]
    s_waitcnt lgkmcnt(0)
    v_mfma_f32_32x32x16_bf16 v[16:31], v[108:111], v[92:95], v[16:31]
    v_mov_b32 v136, 0x3f80
    v_mov_b32 v137, 0x3f800000
    v_mov_b32 v138, 0x3f803f80
    s_nop 7
    v_dot2c_f32_bf16 v0, v112, v136
    v_dot2c_f32_bf16 v1, v112, v137
    v_dot2c_f32_bf16 v2, v113, v136
    v_dot2c_f32_bf16 v3, v113, v137
    v_dot2c_f32_bf16 v4, v114, v136
    v_dot2c_f32_bf16 v5, v114, v137
    v_dot2c_f32_bf16 v6, v115, v136
    v_dot2c_f32_bf16 v7, v115, v137
    v_dot2c_f32_bf16 v8, v116, v136
    v_dot2c_f32_bf16 v9, v116, v137
    v_dot2c_f32_bf16 v10, v117, v136
    v_dot2c_f32_bf16 v11, v117, v137
    v_dot2c_f32_bf16 v12, v118, v136
    v_dot2c_f32_bf16 v13, v118, v137
    v_dot2c_f32_bf16 v14, v119, v136
    v_dot2c_f32_bf16 v15, v119, v137
    v_dot2c_f32_bf16 v16, v120, v136
    v_dot2c_f32_bf16 v17, v120, v137
    v_dot2c_f32_bf16 v18, v121, v136
    v_dot2c_f32_bf16 v19, v121, v137
    v_dot2c_f32_bf16 v20, v122, v136
    v_dot2c_f32_bf16 v21, v122, v137
    v_dot2c_f32_bf16 v22, v123, v136
    v_dot2c_f32_bf16 v23, v123, v137
    v_dot2c_f32_bf16 v24, v124, v136
    v_dot2c_f32_bf16 v25, v124, v137
    v_dot2c_f32_bf16 v26, v125, v136
    v_dot2c_f32_bf16 v27, v125, v137
    v_dot2c_f32_bf16 v28, v126, v136
    v_dot2c_f32_bf16 v29, v126, v137
    v_dot2c_f32_bf16 v30, v127, v136
    v_dot2c_f32_bf16 v31, v127, v137
    s_nop 2
    v_cvt_pk_bf16_f32 v112, v0, v1
    v_cvt_pk_bf16_f32 v113, v2, v3
    v_cvt_pk_bf16_f32 v114, v4, v5
    v_cvt_pk_bf16_f32 v115, v6, v7
    v_cvt_pk_bf16_f32 v116, v8, v9
    v_cvt_pk_bf16_f32 v117, v10, v11
    v_cvt_pk_bf16_f32 v118, v12, v13
    v_cvt_pk_bf16_f32 v119, v14, v15
    v_cvt_pk_bf16_f32 v120, v16, v17
    v_cvt_pk_bf16_f32 v121, v18, v19
    v_cvt_pk_bf16_f32 v122, v20, v21
    v_cvt_pk_bf16_f32 v123, v22, v23
    v_cvt_pk_bf16_f32 v124, v24, v25
    v_cvt_pk_bf16_f32 v125, v26, v27
    v_cvt_pk_bf16_f32 v126, v28, v29
    v_cvt_pk_bf16_f32 v127, v30, v31
    s_cmp_eq_u32 s25, 3
    s_cbranch_scc1 p3_final
    s_add_u32 s53, s52, s61
    s_lshl_b32 s39, s21, 14
    s_lshl_b32 s40, s50, 8
    s_add_u32 s39, s39, s40
    s_add_u32 s54, s39, s65
    buffer_store_dwordx4 v[112:115], v254, s[8:11], s53 offen offset:0 sc1
    buffer_store_dwordx4 v[116:119], v254, s[8:11], s53 offen offset:1024 sc1
    buffer_store_dwordx4 v[120:123], v254, s[8:11], s53 offen offset:2048 sc1
    buffer_store_dwordx4 v[124:127], v254, s[8:11], s53 offen offset:3072 sc1
    v_mov_b32 v140, 0
    v_mov_b32 v141, 0
    v_dot2c_f32_bf16 v140, v112, v138
    v_dot2c_f32_bf16 v141, v112, v112
    v_dot2c_f32_bf16 v140, v113, v138
    v_dot2c_f32_bf16 v141, v113, v113
    v_dot2c_f32_bf16 v140, v114, v138
    v_dot2c_f32_bf16 v141, v114, v114
    v_dot2c_f32_bf16 v140, v115, v138
    v_dot2c_f32_bf16 v141, v115, v115
    v_dot2c_f32_bf16 v140, v116, v138
    v_dot2c_f32_bf16 v141, v116, v116
    v_dot2c_f32_bf16 v140, v117, v138
    v_dot2c_f32_bf16 v141, v117, v117
    v_dot2c_f32_bf16 v140, v118, v138
    v_dot2c_f32_bf16 v141, v118, v118
    v_dot2c_f32_bf16 v140, v119, v138
    v_dot2c_f32_bf16 v141, v119, v119
    v_dot2c_f32_bf16 v140, v120, v138
    v_dot2c_f32_bf16 v141, v120, v120
    v_dot2c_f32_bf16 v140, v121, v138
    v_dot2c_f32_bf16 v141, v121, v121
    v_dot2c_f32_bf16 v140, v122, v138
    v_dot2c_f32_bf16 v141, v122, v122
    v_dot2c_f32_bf16 v140, v123, v138
    v_dot2c_f32_bf16 v141, v123, v123
    v_dot2c_f32_bf16 v140, v124, v138
    v_dot2c_f32_bf16 v141, v124, v124
    v_dot2c_f32_bf16 v140, v125, v138
    v_dot2c_f32_bf16 v141, v125, v125
    v_dot2c_f32_bf16 v140, v126, v138
    v_dot2c_f32_bf16 v141, v126, v126
    v_dot2c_f32_bf16 v140, v127, v138
    v_dot2c_f32_bf16 v141, v127, v127
    s_nop 2
    v_mov_b32 v142, v140
    v_mov_b32 v143, v141
    s_nop 1
    v_permlane32_swap_b32 v140, v142
    v_permlane32_swap_b32 v141, v143
    s_nop 1
    v_add_f32 v140, v140, v142
    v_add_f32 v141, v141, v143
    v_and_b32 v144, 31, v255
    v_lshlrev_b32 v144, 3, v144
    s_mov_b64 exec, 0xffffffff
    buffer_store_dwordx2 v[140:141], v144, s[8:11], s54 offen sc1
    s_mov_b64 exec, -1
    s_add_u32 s25, s25, 1
    s_lshl_b32 s38, s25, 22
    s_mov_b32 s60, s38
    s_add_u32 s61, s60, 0x400000
    s_add_u32 s62, s38, 0x1000000
    s_lshl_b32 s38, s25, 18
    s_add_u32 s64, s38, 0x3500000
    s_add_u32 s65, s64, 0x40000
    s_lshr_b32 s39, s25, 1
    s_lshl_b32 s38, s39, 17
    s_add_u32 s67, s38, 0x3400000
    s_lshl_b32 s38, s39, 21
    s_add_u32 s38, s38, 0x3000000
    s_lshl_b32 s39, s39, 23
    s_add_u32 s39, s39, 0x2000000
    s_bitcmp1_b32 s25, 0
    s_cselect_b32 s63, s39, s38
    s_mul_i32 s38, s25, 0x1800
    s_add_u32 s66, s38, 0x3701800
    s_and_b32 s38, s25, 1
    s_mul_i32 s38, s38, 768
    s_add_u32 s70, s38, 132096
    s_lshl_b32 s39, s23, 13
    v_add_u32 v138, s39, v254
    v_lshrrev_b32 v5, 5, v255
    v_bfe_u32 v6, v255, 2, 2
    v_lshl_add_u32 v5, v5, 2, v6
    v_lshlrev_b32 v5, 7, v5
    v_bfe_u32 v6, v255, 4, 1
    v_bfe_u32 v7, v255, 1, 1
    v_lshl_add_u32 v6, v6, 1, v7
    s_lshl_b32 s39, s24, 2
    v_add_u32 v6, s39, v6
    v_bfe_u32 v7, v255, 3, 1
    v_lshlrev_b32 v7, 2, v7
    v_xor_b32 v6, v6, v7
    v_lshl_add_u32 v5, v6, 4, v5
    v_and_b32 v6, 1, v255
    v_lshl_add_u32 v139, v6, 3, v5
    v_mov_b32 v136, v138
    v_mov_b32 v137, v139
    v_mov_b32 v0, 0
    v_mov_b32 v1, 0
    v_mov_b32 v2, 0
    v_mov_b32 v3, 0
    v_mov_b32 v4, 0
    v_mov_b32 v5, 0
    v_mov_b32 v6, 0
    v_mov_b32 v7, 0
    v_mov_b32 v8, 0
    v_mov_b32 v9, 0
    v_mov_b32 v10, 0
    v_mov_b32 v11, 0
    v_mov_b32 v12, 0
    v_mov_b32 v13, 0
    v_mov_b32 v14, 0
    v_mov_b32 v15, 0
    v_mov_b32 v16, 0
    v_mov_b32 v17, 0
    v_mov_b32 v18, 0
    v_mov_b32 v19, 0
    v_mov_b32 v20, 0
    v_mov_b32 v21, 0
    v_mov_b32 v22, 0
    v_mov_b32 v23, 0
    v_mov_b32 v24, 0
    v_mov_b32 v25, 0
    v_mov_b32 v26, 0
    v_mov_b32 v27, 0
    v_mov_b32 v28, 0
    v_mov_b32 v29, 0
    v_mov_b32 v30, 0
    v_mov_b32 v31, 0
    v_mov_b32 v32, 0
    v_mov_b32 v33, 0
    v_mov_b32 v34, 0
    v_mov_b32 v35, 0
    v_mov_b32 v36, 0
    v_mov_b32 v37, 0
    v_mov_b32 v38, 0
    v_mov_b32 v39, 0
    v_mov_b32 v40, 0
    v_mov_b32 v41, 0
    v_mov_b32 v42, 0
    v_mov_b32 v43, 0
    v_mov_b32 v44, 0
    v_mov_b32 v45, 0
    v_mov_b32 v46, 0
    v_mov_b32 v47, 0
    v_mov_b32 v48, 0
    v_mov_b32 v49, 0
    v_mov_b32 v50, 0
    v_mov_b32 v51, 0
    v_mov_b32 v52, 0
    v_mov_b32 v53, 0
    v_mov_b32 v54, 0
    v_mov_b32 v55, 0
    v_mov_b32 v56, 0
    v_mov_b32 v57, 0
    v_mov_b32 v58, 0
    v_mov_b32 v59, 0
    v_mov_b32 v60, 0
    v_mov_b32 v61, 0
    v_mov_b32 v62, 0
    v_mov_b32 v63, 0
    v_mov_b32 v64, 0
    v_mov_b32 v65, 0
    v_mov_b32 v66, 0
    v_mov_b32 v67, 0
    v_mov_b32 v68, 0
    v_mov_b32 v69, 0
    v_mov_b32 v70, 0
    v_mov_b32 v71, 0
    v_mov_b32 v72, 0
    v_mov_b32 v73, 0
    v_mov_b32 v74, 0
    v_mov_b32 v75, 0
    v_mov_b32 v76, 0
    v_mov_b32 v77, 0
    v_mov_b32 v78, 0
    v_mov_b32 v79, 0
    v_mov_b32 v80, 0
    v_mov_b32 v81, 0
    v_mov_b32 v82, 0
    v_mov_b32 v83, 0
    v_mov_b32 v84, 0
    v_mov_b32 v85, 0
    v_mov_b32 v86, 0
    v_mov_b32 v87, 0
    v_mov_b32 v88, 0
    v_mov_b32 v89, 0
    v_mov_b32 v90, 0
    v_mov_b32 v91, 0
    v_mov_b32 v92, 0
    v_mov_b32 v93, 0
    v_mov_b32 v94, 0
    v_mov_b32 v95, 0
    s_mov_b32 s40, 0
    s_mov_b32 s49, 16
    s_waitcnt vmcnt(0)
    s_barrier
    s_cmp_eq_u32 s22, 0
    s_cbranch_scc0 m_hx
    s_lshl_b32 s38, s20, 7
    s_add_u32 s38, s38, s66
    s_sub_u32 s38, s38, 2048
    s_lshl_b32 s39, s21, 3
    v_mov_b32 v250, s39
    v_mov_b32 v248, s69
    v_not_b32 v249, v248
    s_mov_b64 exec, 1
    buffer_store_dwordx2 v[248:249], v250, s[8:11], s38 offen sc1
    s_mov_b64 exec, -1
    v_and_b32 v250, 15, v255
    v_lshlrev_b32 v250, 3, v250
    s_mov_b32 s39, 65536
    s_not_b32 s71, s69
    buffer_load_dwordx2 v[248:249], v250, s[8:11], s38 offen sc1
poll6:
    s_waitcnt vmcnt(0)
    v_cmp_eq_u32 vcc, s69, v248
    v_cmp_eq_u32 s[72:73], s71, v249
    s_nop 0
    s_and_b64 vcc, vcc, s[72:73]
    s_cmp_eq_u64 vcc, exec
    s_cbranch_scc1 poll6_done
    buffer_load_dwordx2 v[248:249], v250, s[8:11], s38 offen sc1
    s_sub_u32 s39, s39, 1
    s_cmp_lg_u32 s39, 0
    s_cbranch_scc1 poll6
poll6_done:
m_hx:
    s_barrier
    s_branch m_layer
p3_final:
    v_permlane32_swap_b32 v112, v114
    v_permlane32_swap_b32 v113, v115
    v_permlane32_swap_b32 v116, v118
    v_permlane32_swap_b32 v117, v119
    v_permlane32_swap_b32 v120, v122
    v_permlane32_swap_b32 v121, v123
    v_permlane32_swap_b32 v124, v126
    v_permlane32_swap_b32 v125, v127
    s_mov_b32 s16, s36
    s_and_b32 s17, s37, 0xffff
    s_mov_b32 s18, 0x400000
    s_mov_b32 s19, 0x20000
    s_lshl_b32 s39, s21, 7
    s_add_u32 s39, s39, s51
    s_lshl_b32 s40, s22, 12
    s_add_u32 s40, s40, 138240
    v_and_b32 v144, 31, v255
    v_lshrrev_b32 v145, 5, v255
    v_and_b32 v146, 7, v144
    v_lshlrev_b32 v144, 7, v144
    v_add_u32 v144, s40, v144
    v_add_u32 v147, 0, v145
    v_xor_b32 v147, v147, v146
    v_lshl_add_u32 v147, v147, 4, v144
    ds_write_b128 v147, v[112:115]
    v_add_u32 v147, 2, v145
    v_xor_b32 v147, v147, v146
    v_lshl_add_u32 v147, v147, 4, v144
    ds_write_b128 v147, v[116:119]
    v_add_u32 v147, 4, v145
    v_xor_b32 v147, v147, v146
    v_lshl_add_u32 v147, v147, 4, v144
    ds_write_b128 v147, v[120:123]
    v_add_u32 v147, 6, v145
    v_xor_b32 v147, v147, v146
    v_lshl_add_u32 v147, v147, 4, v144
    ds_write_b128 v147, v[124:127]
    v_lshrrev_b32 v145, 3, v255
    v_and_b32 v146, 7, v255
    v_xor_b32 v147, v146, v145
    v_lshlrev_b32 v147, 4, v147
    v_lshl_add_u32 v147, v145, 7, v147
    v_add_u32 v147, s40, v147
    v_lshlrev_b32 v144, 11, v145
    v_lshl_add_u32 v144, v146, 4, v144
    s_waitcnt lgkmcnt(0)
    ds_read_b128 v[148:151], v147 offset:0
    ds_read_b128 v[152:155], v147 offset:1024
    ds_read_b128 v[156:159], v147 offset:2048
    ds_read_b128 v[160:163], v147 offset:3072
    s_waitcnt lgkmcnt(3)
    s_add_u32 s40, s39, 0
    buffer_store_dwordx4 v[148:151], v144, s[16:19], s40 offen nt
    s_waitcnt lgkmcnt(2)
    s_add_u32 s40, s39, 16384
    buffer_store_dwordx4 v[152:155], v144, s[16:19], s40 offen nt
    s_waitcnt lgkmcnt(1)
    s_add_u32 s40, s39, 32768
    buffer_store_dwordx4 v[156:159], v144, s[16:19], s40 offen nt
    s_waitcnt lgkmcnt(0)
    s_add_u32 s40, s39, 49152
    buffer_store_dwordx4 v[160:163], v144, s[16:19], s40 offen nt
    s_waitcnt vmcnt(0)
    s_endpgm
interleave_layers__linear_kernel_hedgehog__mha_block__prompt_kernel_exit:
    s_endpgm
.section .rodata,"a"
.p2align 6
.amdhsa_kernel interleave_layers__linear_kernel_hedgehog__mha_block__prompt_kernel
  .amdhsa_next_free_vgpr 256
  .amdhsa_next_free_sgpr 102
  .amdhsa_accum_offset 256
  .amdhsa_group_segment_fixed_size 0
  .amdhsa_kernarg_size 80
  .amdhsa_user_sgpr_count 2
  .amdhsa_user_sgpr_kernarg_segment_ptr 1
  .amdhsa_system_sgpr_workgroup_id_x 1
.end_amdhsa_kernel
```
